```python
import torch

def _softmax(x, axis=-1):
    return torch.softmax(x, dim=axis)
def _gelu(x):
    return torch.nn.functional.gelu(x, approximate="tanh")
def _silu(x):
    return torch.nn.functional.silu(x)
def _sigmoid(x):
    return torch.sigmoid(x)
def _layernorm(x, axis=-1, eps=1e-5):
    m = x.mean(dim=axis, keepdim=True)
    v = x.var(dim=axis, keepdim=True, unbiased=False)
    return (x - m) / torch.sqrt(v + eps)
def _scatter_add(tgt, idx, src, axis=0):
    return tgt.clone().index_add_(axis, idx, src)
def _segment_sum(src, seg, n):
    out = torch.zeros((n,) + src.shape[1:], dtype=src.dtype)
    return out.index_add_(0, seg, src)
def _pad(x, pw):
    flat = tuple(v for pair in reversed(pw) for v in pair)
    return torch.nn.functional.pad(x, flat)

kernel_name = 'sequential_preLN__sliding_block__moe_arch_mod__prompt'

def setup_inputs():

    _w = (lambda a: (lambda t: t.to(torch.bfloat16) if t.is_floating_point() else t)(torch.as_tensor(a)))
    def _A_setup():
        B, S, D = 1, 2048, 512
        return {
            "x": _w((lambda *s: torch.randn(*s, dtype=torch.bfloat16) * 0.05)(B, S, D)),
            "wqkv": _w((lambda *s: torch.randn(*s, dtype=torch.bfloat16) * 0.05)(D, 3 * D)),
            "wo": _w((lambda *s: torch.randn(*s, dtype=torch.bfloat16) * 0.05)(D, D)),
        }
    _A_in = _A_setup()

    def _B_setup():
        B, S, D, F, C = 1, 2048, 512, 1376, 2
        return {
            "x": _w((lambda *s: torch.randn(*s, dtype=torch.bfloat16) * 0.05)(B, S, D)),
            "w_r": _w((lambda *s: torch.randn(*s, dtype=torch.bfloat16) * 0.05)(D)),
            "w_gate": _w((lambda *s: torch.randn(*s, dtype=torch.bfloat16) * 0.05)(D, F)),
            "w_up": _w((lambda *s: torch.randn(*s, dtype=torch.bfloat16) * 0.05)(D, F)),
            "w_down": _w((lambda *s: torch.randn(*s, dtype=torch.bfloat16) * 0.05)(F, D)),
        }
    _B_in = _B_setup()

    return {
        "A_x": _A_in["x"],
        "A_wqkv": _A_in["wqkv"],
        "A_wo": _A_in["wo"],
        "B_x": _B_in["x"],
        "B_w_r": _B_in["w_r"],
        "B_w_gate": _B_in["w_gate"],
        "B_w_up": _B_in["w_up"],
        "B_w_down": _B_in["w_down"],
    }

def reference(A_x, A_wqkv, A_wo, B_x, B_w_r, B_w_gate, B_w_up, B_w_down):
    def _A_ref(x, wqkv, wo):
        B, S, D = x.shape
        H = 32; Dh = D // H; W = 256
        qkv = (lambda x, *d: x.permute(*d))((x @ wqkv).reshape(B, S, 3, H, Dh), 2, 0, 3, 1, 4)
        q, k, v = qkv[0], qkv[1], qkv[2]
        scores = torch.einsum("bhqd,bhkd->bhqk", q, k) * (Dh ** -0.5)
        idx = torch.arange(S)
        mask = (idx[:, None] - idx[None, :] >= 0) & (idx[:, None] - idx[None, :] < W)
        scores = torch.where(mask[None, None], scores, -1e9)
        p = _softmax(scores, axis=-1)
        o = torch.einsum("bhqk,bhkd->bhqd", p, v)
        return (lambda x, *d: x.permute(*d))(o, 0, 2, 1, 3).reshape(B, S, D) @ wo

    def _B_ref(x, w_r, w_gate, w_up, w_down):
        B, S, D = x.shape
        C = 2
        r = x @ w_r
        idx = torch.argsort(-r, axis=-1)[:, :C]
        idx_e = (lambda x, n, axis: torch.repeat_interleave(x, n, dim=axis))(idx.reshape(B, C, 1), D, axis=2)
        x_sel = (lambda x, i, axis: torch.take_along_dim(x, i, dim=axis))(x, idx_e, axis=1)
        g = _silu(x_sel @ w_gate)
        u = x_sel @ w_up
        y = (g * u) @ w_down
        r_sel = _sigmoid((lambda x, i, axis: torch.take_along_dim(x, i, dim=axis))(r, idx, axis=1))
        y = y * r_sel.reshape(B, C, 1)
        b_off = (torch.arange(B) * S).reshape(B, 1)
        flat_idx = (idx + b_off).reshape(B * C)
        zero = (x * 0.0).reshape(B * S, D)
        upd = _scatter_add(zero, flat_idx, y.reshape(B * C, D), axis=0)
        return x + upd.reshape(B, S, D)

    x = A_x
    h = x + _A_ref(_layernorm(x, axis=-1), A_wqkv, A_wo)
    h2 = h + _B_ref(_layernorm(h, axis=-1), B_w_r, B_w_gate, B_w_up, B_w_down)
    return h2
```

```asm
; @launch grid=(256,1,1) block=(512,1,1) lds=163840
.amdgcn_target "amdgcn-amd-amdhsa--gfx950"
.text
.globl sequential_preLN__sliding_block__moe_arch_mod__prompt_kernel
.p2align 8
.type sequential_preLN__sliding_block__moe_arch_mod__prompt_kernel,@function
sequential_preLN__sliding_block__moe_arch_mod__prompt_kernel:
    s_cmp_ge_u32 s2, 256
    s_cbranch_scc1 K_END
    s_load_dwordx16 s[8:23], s[0:1], 0
    s_load_dwordx4 s[24:27], s[0:1], 64
    s_load_dwordx2 s[28:29], s[0:1], 80
    v_and_b32 v1, 63, v0
    v_lshrrev_b32 v8, 6, v0
    v_lshlrev_b32 v5, 4, v1
    v_readfirstlane_b32 s52, v8
    s_and_b32 s61, s2, 7
    s_lshr_b32 s62, s2, 3
    s_lshr_b32 s55, s61, 1
    s_lshr_b32 s63, s62, 3
    s_lshl_b32 s64, s63, 2
    s_add_u32 s55, s55, s64
    s_and_b32 s56, s61, 1
    s_lshl_b32 s56, s56, 3
    s_and_b32 s3, s62, 7
    s_add_u32 s56, s56, s3
    s_lshl_b32 s63, s63, 1
    s_add_u32 s3, s3, s63
    s_and_b32 s3, s3, 7
    s_and_b32 s53, s52, 3
    s_lshr_b32 s54, s52, 2
    s_lshl_b32 s58, s55, 4
    s_add_u32 s58, s58, s56
    s_cmp_eq_u32 s54, 0
    s_cbranch_scc0 K_PRO_LD
    s_lshl_b32 s61, s58, 2
    s_add_u32 s61, s61, s53
    s_lshl_b32 s62, s61, 11
    v_mov_b32 v8, -1
    v_mov_b32 v9, -1
    v_mov_b32 v10, -1
    v_mov_b32 v11, -1
    s_waitcnt lgkmcnt(0)
    s_mov_b32 s32, s8
    s_mov_b32 s33, s9
    s_mov_b32 s34, 0x200000
    s_mov_b32 s35, 0x20000
    buffer_load_dwordx4 v[176:179], v5, s[32:35], s62 offen
    buffer_load_dwordx4 v[180:183], v5, s[32:35], s62 offen offset:1024
    s_mov_b32 s40, s28
    s_mov_b32 s41, s29
    s_mov_b32 s42, 0x10000000
    s_mov_b32 s43, 0x20000
    s_or_b32 s61, s2, s52
    s_cmp_lg_u32 s61, 0
    s_cbranch_scc1 K_NONONCE
    s_mov_b32 s44, s26
    s_mov_b32 s45, s27
    s_mov_b32 s46, 0x100
    s_mov_b32 s47, 0x20000
    s_memrealtime s[68:69]
    s_waitcnt lgkmcnt(0)
    s_or_b32 s69, s69, 0x80000000
    v_mov_b32 v12, s68
    v_mov_b32 v13, s69
    s_mov_b64 exec, 1
    buffer_store_dwordx2 v[12:13], v5, s[44:47], 0 offen sc1
    s_mov_b64 exec, -1
K_NONONCE:
    s_cmp_lg_u32 s53, 0
    s_cbranch_scc1 K_NOCLRP
    s_lshl_b32 s61, s58, 10
    s_add_u32 s61, s61, 0x800000
    buffer_store_dwordx4 v[8:11], v5, s[40:43], s61 offen offset:0 sc1
    s_add_u32 s61, s61, 0xc0000
    buffer_store_dwordx4 v[8:11], v5, s[40:43], s61 offen offset:0 sc1
K_NOCLRP:
    s_cmp_lg_u32 s2, 1
    s_cbranch_scc1 K_PRO_DONE
    s_lshl_b32 s61, s53, 11
    s_add_u32 s61, s61, 0x840000
    buffer_store_dwordx4 v[8:11], v5, s[40:43], s61 offen offset:0 sc1
    buffer_store_dwordx4 v[8:11], v5, s[40:43], s61 offen offset:1024 sc1
    s_branch K_PRO_DONE
K_PRO_LD:
    v_lshrrev_b32 v8, 3, v1
    v_lshrrev_b32 v9, 1, v8
    v_and_b32 v10, 7, v1
    v_xor_b32 v10, v10, v9
    v_lshlrev_b32 v10, 4, v10
    v_lshl_add_u32 v22, v8, 10, v10
    v_xor_b32 v23, 64, v22
    v_add_u32 v23, 7168, v23
    v_add_u32 v24, 14336, v22
    v_add_u32 v25, 14336, v23
    s_lshl_b32 s30, s55, 17
    s_lshl_b32 s61, s53, 15
    s_add_u32 s30, s30, s61
    s_movk_i32 s62, 0x1556
    v_mul_u32_u24 v9, s62, v1
    v_lshrrev_b32 v9, 16, v9
    v_mul_u32_u24 v10, 12, v9
    v_sub_u32 v10, v1, v10
    v_lshrrev_b32 v11, 2, v10
    v_and_b32 v10, 3, v10
    v_lshlrev_b32 v10, 4, v10
    v_lshl_add_u32 v10, v11, 10, v10
    v_mul_u32_u24 v9, 0xc00, v9
    v_add_u32 v14, v9, v10
    v_add_u32 v8, 64, v1
    v_mul_u32_u24 v9, s62, v8
    v_lshrrev_b32 v9, 16, v9
    v_mul_u32_u24 v10, 12, v9
    v_sub_u32 v10, v8, v10
    v_lshrrev_b32 v11, 2, v10
    v_and_b32 v10, 3, v10
    v_lshlrev_b32 v10, 4, v10
    v_lshl_add_u32 v10, v11, 10, v10
    v_mul_u32_u24 v9, 0xc00, v9
    v_add_u32 v15, v9, v10
    v_subrev_u32 v15, 1024, v15
    v_add_u32 v8, 128, v1
    v_mul_u32_u24 v9, s62, v8
    v_lshrrev_b32 v9, 16, v9
    v_mul_u32_u24 v10, 12, v9
    v_sub_u32 v10, v8, v10
    v_lshrrev_b32 v11, 2, v10
    v_and_b32 v10, 3, v10
    v_lshlrev_b32 v10, 4, v10
    v_lshl_add_u32 v10, v11, 10, v10
    v_mul_u32_u24 v9, 0xc00, v9
    v_add_u32 v16, v9, v10
    v_subrev_u32 v16, 2048, v16
    s_lshl_b32 s31, s56, 6
    s_mul_i32 s61, s53, 49152
    s_add_u32 s31, s31, s61
    s_lshl_b32 s6, s53, 12
    s_lshl_b32 s7, s53, 10
    s_sub_u32 s7, 16384, s7
    s_waitcnt lgkmcnt(0)
    s_mov_b32 s32, s8
    s_mov_b32 s33, s9
    s_mov_b32 s34, 0x200000
    s_mov_b32 s35, 0x20000
    s_mov_b32 s36, s10
    s_mov_b32 s37, s11
    s_mov_b32 s38, 0x180000
    s_mov_b32 s39, 0x20000
    s_lshl_b32 s4, s3, 7
    s_mov_b32 m0, s6
    s_add_u32 s4, s4, s30
    buffer_load_dwordx4 v22, s[32:35], s4 offen offset:0 lds
    v_and_b32 v2, 31, v1
    v_lshrrev_b32 v3, 5, v1
    v_and_b32 v4, 0x13, v2
    v_and_b32 v48, 4, v2
    v_lshl_or_b32 v4, v48, 1, v4
    v_and_b32 v48, 8, v2
    v_lshrrev_b32 v48, 1, v48
    v_or_b32 v4, v4, v48
    v_mov_b32 v6, 0x3f803f80
    s_add_u32 s64, s55, 1
    s_and_b32 s64, s64, 15
    s_mul_i32 s5, s3, 196608
    s_add_u32 s61, s6, s7
    buffer_load_dwordx4 v23, s[32:35], s4 offen offset:1024 lds
    s_lshl_b32 s15, s64, 1
    s_lshr_b32 s62, s56, 3
    s_add_u32 s15, s15, s62
    s_and_b32 s14, s56, 7
    v_lshrrev_b32 v48, 3, v1
    v_and_b32 v49, 3, v48
    v_lshrrev_b32 v48, 2, v48
    v_lshl_add_u32 v49, v48, 3, v49
    s_lshr_b32 s64, s53, 1
    s_lshl_b32 s64, s64, 4
    s_and_b32 s62, s53, 1
    s_add_u32 s5, s5, s31
    s_add_u32 s3, s3, 1
    buffer_load_dwordx4 v24, s[32:35], s4 offen offset:2048 lds
    s_lshl_b32 s62, s62, 2
    s_add_u32 s64, s64, s62
    s_lshl_b32 s62, s15, 6
    s_add_u32 s64, s64, s62
    s_add_u32 s64, s64, 32
    v_add_u32 v7, s64, v49
    s_and_b32 s64, s2, 7
    s_lshr_b32 s62, s2, 3
    s_mul_i32 s60, s64, 11
    s_add_u32 s60, s60, s62
    s_cmp_lt_u32 s62, 11
    s_cselect_b32 s59, 1, 0
    s_and_b32 s3, s3, 7
    s_add_u32 s6, s6, 28672
    buffer_load_dwordx4 v25, s[32:35], s4 offen offset:3072 lds
    s_cmp_lt_u32 s60, 86
    s_cselect_b32 s59, s59, 0
    s_sub_u32 s62, s62, 11
    s_lshl_b32 s64, s64, 2
    s_add_u32 s64, s64, s62
    s_cmp_lt_u32 s62, 4
    s_cselect_b32 s59, 2, s59
    s_cmp_lt_u32 s62, 4
    s_cselect_b32 s60, s64, s60
    s_lshl_b32 s64, s58, 2
    s_add_u32 s64, s64, s53
    s_mov_b32 m0, s61
    s_nop 0
    buffer_load_dwordx4 v14, s[36:39], s5 offen offset:0 lds
    s_lshl_b32 s64, s64, 6
    v_lshl_add_u32 v184, v3, 4, s64
    s_lshl_b32 s64, s55, 2
    s_add_u32 s64, s64, s53
    s_lshl_b32 s64, s64, 10
    v_lshrrev_b32 v48, 1, v4
    v_lshl_add_u32 v185, v48, 6, s64
    v_and_b32 v48, 1, v4
    v_lshl_add_u32 v185, v48, 4, v185
    s_lshr_b32 s64, s15, 1
    s_lshl_b32 s64, s64, 12
    s_cmp_ge_u32 s6, 143360
    s_cselect_b32 s61, 143360, 0
    s_sub_u32 s6, s6, s61
    buffer_load_dwordx4 v15, s[36:39], s5 offen offset:1024 lds
    v_and_b32 v48, 15, v1
    v_lshl_add_u32 v186, v48, 8, s64
    s_mov_b32 s66, 0
    s_sub_u32 s57, 3, s53
    s_mov_b32 s40, s28
    s_mov_b32 s41, s29
    s_mov_b32 s42, 0x10000000
    s_mov_b32 s43, 0x20000
    s_mov_b32 s44, s26
    s_mov_b32 s45, s27
    s_mov_b32 s46, 0x100
    buffer_load_dwordx4 v16, s[36:39], s5 offen offset:2048 lds
    s_mov_b32 s47, 0x20000
    v_lshlrev_b32 v255, 3, v3
    v_sub_u32 v255, v4, v255
    v_mov_b32 v42, 0xf149f2ca
    v_mov_b32 v43, 0
    v_cmp_le_i32 vcc, 0, v255
    v_cmp_le_i32 s[68:69], 1, v255
    s_nop 0
    v_cndmask_b32 v200, v42, v43, vcc
    v_cndmask_b32 v201, v42, v43, s[68:69]
    v_cmp_le_i32 vcc, 2, v255
    v_cmp_le_i32 s[68:69], 3, v255
    s_nop 0
    v_cndmask_b32 v202, v42, v43, vcc
    v_cndmask_b32 v203, v42, v43, s[68:69]
    s_lshl_b32 s4, s3, 7
    s_mov_b32 m0, s6
    s_add_u32 s4, s4, s30
    buffer_load_dwordx4 v22, s[32:35], s4 offen offset:0 lds
    v_cmp_le_i32 vcc, 4, v255
    v_cmp_le_i32 s[68:69], 5, v255
    s_nop 0
    v_cndmask_b32 v204, v42, v43, vcc
    v_cndmask_b32 v205, v42, v43, s[68:69]
    v_cmp_le_i32 vcc, 6, v255
    v_cmp_le_i32 s[68:69], 7, v255
    s_nop 0
    v_cndmask_b32 v206, v42, v43, vcc
    v_cndmask_b32 v207, v42, v43, s[68:69]
    v_cmp_le_i32 vcc, 16, v255
    v_cmp_le_i32 s[68:69], 17, v255
    s_nop 0
    v_cndmask_b32 v208, v42, v43, vcc
    v_cndmask_b32 v209, v42, v43, s[68:69]
    s_mul_i32 s5, s3, 196608
    s_add_u32 s61, s6, s7
    buffer_load_dwordx4 v23, s[32:35], s4 offen offset:1024 lds
    v_cmp_le_i32 vcc, 18, v255
    v_cmp_le_i32 s[68:69], 19, v255
    s_nop 0
    v_cndmask_b32 v210, v42, v43, vcc
    v_cndmask_b32 v211, v42, v43, s[68:69]
    v_cmp_le_i32 vcc, 20, v255
    v_cmp_le_i32 s[68:69], 21, v255
    s_nop 0
    v_cndmask_b32 v212, v42, v43, vcc
    v_cndmask_b32 v213, v42, v43, s[68:69]
    v_cmp_le_i32 vcc, 22, v255
    v_cmp_le_i32 s[68:69], 23, v255
    s_nop 0
    v_cndmask_b32 v214, v42, v43, vcc
    v_cndmask_b32 v215, v42, v43, s[68:69]
    s_add_u32 s5, s5, s31
    s_add_u32 s3, s3, 1
    buffer_load_dwordx4 v24, s[32:35], s4 offen offset:2048 lds
    v_add_u32 v253, 1024, v5
    v_add_u32 v254, 24832, v5
    v_mov_b32 v216, v6
    v_mov_b32 v217, v6
    v_mov_b32 v218, v6
    v_mov_b32 v219, v6
    v_mov_b32 v220, v6
    v_mov_b32 v221, v6
    v_mov_b32 v222, v6
    v_mov_b32 v223, v6
    v_mov_b32 v224, v6
    s_and_b32 s3, s3, 7
    s_add_u32 s6, s6, 28672
    buffer_load_dwordx4 v25, s[32:35], s4 offen offset:3072 lds
    v_mov_b32 v225, v6
    v_mov_b32 v226, v6
    v_mov_b32 v227, v6
    v_mov_b32 v228, v6
    v_mov_b32 v229, v6
    v_mov_b32 v230, v6
    v_mov_b32 v231, v6
    v_mov_b32 v232, 0
    v_mov_b32 v233, 0
    v_mov_b32 v234, 0
    v_mov_b32 v235, 0
    s_mov_b32 m0, s61
    s_nop 0
    buffer_load_dwordx4 v14, s[36:39], s5 offen offset:0 lds
    v_mov_b32 v236, 0
    v_mov_b32 v237, 0
    v_mov_b32 v238, 0
    v_mov_b32 v239, 0
    v_mov_b32 v240, 0
    v_mov_b32 v241, 0
    v_mov_b32 v242, 0
    v_mov_b32 v243, 0
    v_mov_b32 v244, 0
    v_mov_b32 v245, 0
    v_mov_b32 v246, 0
    s_cmp_ge_u32 s6, 143360
    s_cselect_b32 s61, 143360, 0
    s_sub_u32 s6, s6, s61
    buffer_load_dwordx4 v15, s[36:39], s5 offen offset:1024 lds
    v_mov_b32 v247, 0
    s_lshl_b32 s64, s53, 4
    s_add_u32 s64, s64, 153088
    v_lshl_add_u32 v43, v3, 3, s64
    s_mov_b32 s67, 0
    buffer_load_dwordx4 v16, s[36:39], s5 offen offset:2048 lds
    s_branch K_LOOP1
K_PRO_DONE:
    v_and_b32 v2, 31, v1
    v_lshrrev_b32 v3, 5, v1
    v_and_b32 v4, 0x13, v2
    v_and_b32 v48, 4, v2
    v_lshl_or_b32 v4, v48, 1, v4
    v_and_b32 v48, 8, v2
    v_lshrrev_b32 v48, 1, v48
    v_or_b32 v4, v4, v48
    v_mov_b32 v6, 0x3f803f80
    s_add_u32 s61, s55, 1
    s_and_b32 s61, s61, 15
    s_lshl_b32 s15, s61, 1
    s_lshr_b32 s62, s56, 3
    s_add_u32 s15, s15, s62
    s_and_b32 s14, s56, 7
    v_lshrrev_b32 v48, 3, v1
    v_and_b32 v49, 3, v48
    v_lshrrev_b32 v48, 2, v48
    v_lshl_add_u32 v49, v48, 3, v49
    s_lshr_b32 s61, s53, 1
    s_lshl_b32 s61, s61, 4
    s_and_b32 s62, s53, 1
    s_lshl_b32 s62, s62, 2
    s_add_u32 s61, s61, s62
    s_lshl_b32 s62, s15, 6
    s_add_u32 s61, s61, s62
    v_add_u32 v7, s61, v49
    s_and_b32 s61, s2, 7
    s_lshr_b32 s62, s2, 3
    s_mul_i32 s60, s61, 11
    s_add_u32 s60, s60, s62
    s_cmp_lt_u32 s62, 11
    s_cselect_b32 s59, 1, 0
    s_cmp_lt_u32 s60, 86
    s_cselect_b32 s59, s59, 0
    s_sub_u32 s62, s62, 11
    s_lshl_b32 s61, s61, 2
    s_add_u32 s61, s61, s62
    s_cmp_lt_u32 s62, 4
    s_cselect_b32 s59, 2, s59
    s_cmp_lt_u32 s62, 4
    s_cselect_b32 s60, s61, s60
    v_bfe_u32 v50, v1, 2, 2
    v_lshl_add_u32 v50, v3, 3, v50
    v_mul_u32_u24 v51, 192, v50
    v_bfe_u32 v50, v1, 4, 1
    v_lshl_add_u32 v51, v50, 5, v51
    v_and_b32 v50, 1, v1
    v_lshl_add_u32 v51, v50, 4, v51
    v_bfe_u32 v50, v1, 1, 1
    v_lshl_add_u32 v51, v50, 3, v51
    v_bfe_u32 v48, v4, 1, 3
    v_xor_b32 v48, v48, v3
    v_lshlrev_b32 v48, 4, v48
    s_lshl_b32 s61, s53, 12
    v_lshl_add_u32 v49, v4, 7, s61
    s_add_u32 s61, s53, 0
    s_and_b32 s61, s61, 3
    s_lshl_b32 s62, s61, 5
    s_mul_i32 s61, s61, 3072
    s_add_u32 s61, s61, 16384
    v_xor_b32 v50, s62, v48
    v_add_u32 v26, v49, v50
    v_add_u32 v34, s61, v51
    v_mov_b32 v30, v26
    v_mov_b32 v38, v34
    s_add_u32 s61, s53, 1
    s_and_b32 s61, s61, 3
    s_lshl_b32 s62, s61, 5
    s_mul_i32 s61, s61, 3072
    s_add_u32 s61, s61, 16384
    v_xor_b32 v50, s62, v48
    v_add_u32 v27, v49, v50
    v_add_u32 v35, s61, v51
    v_mov_b32 v31, v27
    v_mov_b32 v39, v35
    s_add_u32 s61, s53, 2
    s_and_b32 s61, s61, 3
    s_lshl_b32 s62, s61, 5
    s_mul_i32 s61, s61, 3072
    s_add_u32 s61, s61, 16384
    v_xor_b32 v50, s62, v48
    v_add_u32 v28, v49, v50
    v_add_u32 v36, s61, v51
    v_mov_b32 v32, v28
    v_mov_b32 v40, v36
    s_add_u32 s61, s53, 3
    s_and_b32 s61, s61, 3
    s_lshl_b32 s62, s61, 5
    s_mul_i32 s61, s61, 3072
    s_add_u32 s61, s61, 16384
    v_xor_b32 v50, s62, v48
    v_add_u32 v29, v49, v50
    v_add_u32 v37, s61, v51
    v_mov_b32 v33, v29
    v_mov_b32 v41, v37
    v_mov_b32 v44, 0x3f803f80
    v_mov_b32 v45, 0x3f803f80
    v_mov_b32 v188, 0
    v_mov_b32 v189, 0
    v_mov_b32 v190, 0
    v_mov_b32 v191, 0
    v_mov_b32 v192, 0
    v_mov_b32 v193, 0
    v_mov_b32 v194, 0
    v_mov_b32 v195, 0
    v_mov_b32 v196, 0
    v_mov_b32 v197, 0
    v_mov_b32 v198, 0
    v_mov_b32 v199, 0
    s_lshl_b32 s61, s53, 2
    s_add_u32 s61, s61, 153600
    v_lshl_add_u32 v184, v2, 4, s61
    v_mov_b32 v128, 0
    v_mov_b32 v129, 0
    v_mov_b32 v130, 0
    v_mov_b32 v131, 0
    v_mov_b32 v132, 0
    v_mov_b32 v133, 0
    v_mov_b32 v134, 0
    v_mov_b32 v135, 0
    v_mov_b32 v136, 0
    v_mov_b32 v137, 0
    v_mov_b32 v138, 0
    v_mov_b32 v139, 0
    v_mov_b32 v140, 0
    v_mov_b32 v141, 0
    v_mov_b32 v142, 0
    v_mov_b32 v143, 0
    v_mov_b32 v144, 0
    v_mov_b32 v145, 0
    v_mov_b32 v146, 0
    v_mov_b32 v147, 0
    v_mov_b32 v148, 0
    v_mov_b32 v149, 0
    v_mov_b32 v150, 0
    v_mov_b32 v151, 0
    v_mov_b32 v152, 0
    v_mov_b32 v153, 0
    v_mov_b32 v154, 0
    v_mov_b32 v155, 0
    v_mov_b32 v156, 0
    v_mov_b32 v157, 0
    v_mov_b32 v158, 0
    v_mov_b32 v159, 0
    v_mov_b32 v160, 0
    v_mov_b32 v161, 0
    v_mov_b32 v162, 0
    v_mov_b32 v163, 0
    v_mov_b32 v164, 0
    v_mov_b32 v165, 0
    v_mov_b32 v166, 0
    v_mov_b32 v167, 0
    v_mov_b32 v168, 0
    v_mov_b32 v169, 0
    v_mov_b32 v170, 0
    v_mov_b32 v171, 0
    v_mov_b32 v172, 0
    v_mov_b32 v173, 0
    v_mov_b32 v174, 0
    v_mov_b32 v175, 0
    v_mov_b32 v80, 0
    v_mov_b32 v81, 0
    v_mov_b32 v82, 0
    v_mov_b32 v83, 0
    v_mov_b32 v84, 0
    v_mov_b32 v85, 0
    v_mov_b32 v86, 0
    v_mov_b32 v87, 0
    v_mov_b32 v88, 0
    v_mov_b32 v89, 0
    v_mov_b32 v90, 0
    v_mov_b32 v91, 0
    v_mov_b32 v92, 0
    v_mov_b32 v93, 0
    v_mov_b32 v94, 0
    v_mov_b32 v95, 0
    v_mov_b32 v96, 0
    v_mov_b32 v97, 0
    v_mov_b32 v98, 0
    v_mov_b32 v99, 0
    v_mov_b32 v100, 0
    v_mov_b32 v101, 0
    v_mov_b32 v102, 0
    v_mov_b32 v103, 0
    v_mov_b32 v104, 0
    v_mov_b32 v105, 0
    v_mov_b32 v106, 0
    v_mov_b32 v107, 0
    v_mov_b32 v108, 0
    v_mov_b32 v109, 0
    v_mov_b32 v110, 0
    v_mov_b32 v111, 0
    s_mov_b32 s65, 0
    s_mov_b32 s57, s53
    v_lshlrev_b32 v255, 3, v3
    v_sub_u32 v255, v4, v255
    v_mov_b32 v42, 0xf149f2ca
    v_mov_b32 v43, 0
    v_cmp_le_i32 vcc, 0, v255
    v_cmp_le_i32 s[68:69], 1, v255
    s_nop 0
    v_cndmask_b32 v200, v42, v43, vcc
    v_cndmask_b32 v201, v42, v43, s[68:69]
    v_cmp_le_i32 vcc, 2, v255
    v_cmp_le_i32 s[68:69], 3, v255
    s_nop 0
    v_cndmask_b32 v202, v42, v43, vcc
    v_cndmask_b32 v203, v42, v43, s[68:69]
    v_cmp_le_i32 vcc, 4, v255
    v_cmp_le_i32 s[68:69], 5, v255
    s_nop 0
    v_cndmask_b32 v204, v42, v43, vcc
    v_cndmask_b32 v205, v42, v43, s[68:69]
    v_cmp_le_i32 vcc, 6, v255
    v_cmp_le_i32 s[68:69], 7, v255
    s_nop 0
    v_cndmask_b32 v206, v42, v43, vcc
    v_cndmask_b32 v207, v42, v43, s[68:69]
    v_cmp_le_i32 vcc, 16, v255
    v_cmp_le_i32 s[68:69], 17, v255
    s_nop 0
    v_cndmask_b32 v208, v42, v43, vcc
    v_cndmask_b32 v209, v42, v43, s[68:69]
    v_cmp_le_i32 vcc, 18, v255
    v_cmp_le_i32 s[68:69], 19, v255
    s_nop 0
    v_cndmask_b32 v210, v42, v43, vcc
    v_cndmask_b32 v211, v42, v43, s[68:69]
    v_cmp_le_i32 vcc, 20, v255
    v_cmp_le_i32 s[68:69], 21, v255
    s_nop 0
    v_cndmask_b32 v212, v42, v43, vcc
    v_cndmask_b32 v213, v42, v43, s[68:69]
    v_cmp_le_i32 vcc, 22, v255
    v_cmp_le_i32 s[68:69], 23, v255
    s_nop 0
    v_cndmask_b32 v214, v42, v43, vcc
    v_cndmask_b32 v215, v42, v43, s[68:69]
    v_add_u32 v253, 0, v5
    v_add_u32 v254, 24576, v5
    v_mov_b32 v216, v6
    v_mov_b32 v217, v6
    v_mov_b32 v218, v6
    v_mov_b32 v219, v6
    v_mov_b32 v220, v6
    v_mov_b32 v221, v6
    v_mov_b32 v222, v6
    v_mov_b32 v223, v6
    v_mov_b32 v224, v6
    v_mov_b32 v225, v6
    v_mov_b32 v226, v6
    v_mov_b32 v227, v6
    v_mov_b32 v228, v6
    v_mov_b32 v229, v6
    v_mov_b32 v230, v6
    v_mov_b32 v231, v6
    v_mov_b32 v232, 0
    v_mov_b32 v233, 0
    v_mov_b32 v234, 0
    v_mov_b32 v235, 0
    v_mov_b32 v236, 0
    v_mov_b32 v237, 0
    v_mov_b32 v238, 0
    v_mov_b32 v239, 0
    v_mov_b32 v240, 0
    v_mov_b32 v241, 0
    v_mov_b32 v242, 0
    v_mov_b32 v243, 0
    v_mov_b32 v244, 0
    v_mov_b32 v245, 0
    v_mov_b32 v246, 0
    v_mov_b32 v247, 0
    s_lshl_b32 s61, s53, 4
    s_add_u32 s61, s61, 153088
    v_lshl_add_u32 v43, v3, 3, s61
    s_mov_b32 s67, 0
    s_waitcnt vmcnt(0)
    v_dot2_f32_bf16 v48, v176, v6, 0
    v_dot2_f32_bf16 v49, v176, v176, 0
    v_dot2_f32_bf16 v50, v180, v6, 0
    v_dot2_f32_bf16 v51, v180, v180, 0
    v_dot2_f32_bf16 v48, v177, v6, v48
    v_dot2_f32_bf16 v49, v177, v177, v49
    v_dot2_f32_bf16 v50, v181, v6, v50
    v_dot2_f32_bf16 v51, v181, v181, v51
    v_dot2_f32_bf16 v48, v178, v6, v48
    v_dot2_f32_bf16 v49, v178, v178, v49
    v_dot2_f32_bf16 v50, v182, v6, v50
    v_dot2_f32_bf16 v51, v182, v182, v51
    v_dot2_f32_bf16 v48, v179, v6, v48
    v_dot2_f32_bf16 v49, v179, v179, v49
    v_dot2_f32_bf16 v50, v183, v6, v50
    v_dot2_f32_bf16 v51, v183, v183, v51
    s_nop 2
    v_permlane32_swap_b32 v48, v50
    v_permlane32_swap_b32 v49, v51
    s_nop 0
    v_add_f32 v48, v48, v50
    v_add_f32 v49, v49, v51
    s_nop 1
    v_permlane16_swap_b32 v48, v49
    s_nop 0
    v_add_f32 v48, v48, v49
    s_nop 1
    v_add_f32_dpp v48, v48, v48 quad_perm:[1,0,3,2] row_mask:0xf bank_mask:0xf
    s_nop 1
    v_add_f32_dpp v48, v48, v48 quad_perm:[2,3,0,1] row_mask:0xf bank_mask:0xf
    s_nop 1
    v_add_f32_dpp v48, v48, v48 row_half_mirror row_mask:0xf bank_mask:0xf
    s_nop 1
    v_add_f32_dpp v48, v48, v48 row_mirror row_mask:0xf bank_mask:0xf
    v_mov_b32 v49, v48
    s_nop 1
    v_permlane16_swap_b32 v48, v49
    s_nop 0
    v_mul_f32 v48, 0x3b000000, v48
    v_mul_f32 v49, 0x3b000000, v49
    v_fma_f32 v49, -v48, v48, v49
    v_max_f32 v49, 0, v49
    v_add_f32 v49, 0x3727c5ac, v49
    v_rsq_f32 v49, v49
    s_nop 0
    v_mov_b32 v176, v49
    v_mul_f32_e64 v177, -v48, v49
    ds_write_b64 v43, v[176:177]
    s_waitcnt lgkmcnt(0)
K_LOOP0:
    s_barrier
    s_waitcnt lgkmcnt(7)
    v_mfma_f32_32x32x16_bf16 v[160:175], v[88:91], v[80:83], v[160:175]
    ds_read_b128 v[48:51], v30
    ds_read_b64_tr_b16 v[56:57], v38 offset:64
    ds_read_b64_tr_b16 v[58:59], v38 offset:832
    ds_read_b64_tr_b16 v[60:61], v38 offset:128
    v_mfma_f32_32x32x16_bf16 v[128:143], v[80:83], v[92:95], v[128:143]
    ds_read_b64_tr_b16 v[62:63], v38 offset:896
    ds_read_b64_tr_b16 v[52:53], v38 offset:0
    ds_read_b64_tr_b16 v[54:55], v38 offset:768
    s_add_u32 s65, s65, 28672
    v_mfma_f32_32x32x16_bf16 v[144:159], v[84:87], v[80:83], v[144:159]
    s_cmp_eq_u32 s65, 143360
    s_cselect_b32 s65, 0, s65
    s_add_u32 s67, s67, 1
    s_waitcnt lgkmcnt(7)
    v_mfma_f32_32x32x16_bf16 v[160:175], v[104:107], v[96:99], v[160:175]
    ds_read_b128 v[64:67], v31
    ds_read_b64_tr_b16 v[72:73], v39 offset:64
    ds_read_b64_tr_b16 v[74:75], v39 offset:832
    ds_read_b64_tr_b16 v[76:77], v39 offset:128
    v_mfma_f32_32x32x16_bf16 v[128:143], v[96:99], v[108:111], v[128:143]
    ds_read_b64_tr_b16 v[78:79], v39 offset:896
    ds_read_b64_tr_b16 v[68:69], v39 offset:0
    ds_read_b64_tr_b16 v[70:71], v39 offset:768
    v_add_u32 v30, s65, v26
    v_mfma_f32_32x32x16_bf16 v[144:159], v[100:103], v[96:99], v[144:159]
    v_add_u32 v38, s65, v34
    v_add_u32 v31, s65, v27
    v_add_u32 v39, s65, v35
    s_waitcnt lgkmcnt(7)
    v_mfma_f32_32x32x16_bf16 v[160:175], v[56:59], v[48:51], v[160:175]
    ds_read_b128 v[80:83], v32
    ds_read_b64_tr_b16 v[88:89], v40 offset:64
    ds_read_b64_tr_b16 v[90:91], v40 offset:832
    ds_read_b64_tr_b16 v[92:93], v40 offset:128
    ds_read_b64_tr_b16 v[94:95], v40 offset:896
    v_mfma_f32_32x32x16_bf16 v[128:143], v[48:51], v[60:63], v[128:143]
    ds_read_b64_tr_b16 v[84:85], v40 offset:0
    ds_read_b64_tr_b16 v[86:87], v40 offset:768
    ds_read_b128 v[96:99], v33
    ds_read_b64_tr_b16 v[104:105], v41 offset:64
    ds_read_b64_tr_b16 v[106:107], v41 offset:832
    v_mfma_f32_32x32x16_bf16 v[144:159], v[52:55], v[48:51], v[144:159]
    ds_read_b64_tr_b16 v[108:109], v41 offset:128
    ds_read_b64_tr_b16 v[110:111], v41 offset:896
    ds_read_b64_tr_b16 v[100:101], v41 offset:0
    ds_read_b64_tr_b16 v[102:103], v41 offset:768
    v_mfma_f32_4x4x4_16b_bf16 v[188:191], v[44:45], v[52:53], v[188:191]
    v_mfma_f32_4x4x4_16b_bf16 v[192:195], v[44:45], v[56:57], v[192:195]
    v_mfma_f32_4x4x4_16b_bf16 v[196:199], v[44:45], v[60:61], v[196:199]
    v_mfma_f32_4x4x4_16b_bf16 v[188:191], v[44:45], v[54:55], v[188:191]
    v_mfma_f32_4x4x4_16b_bf16 v[192:195], v[44:45], v[58:59], v[192:195]
    v_mfma_f32_4x4x4_16b_bf16 v[196:199], v[44:45], v[62:63], v[196:199]
    s_waitcnt lgkmcnt(14)
    v_mfma_f32_32x32x16_bf16 v[160:175], v[72:75], v[64:67], v[160:175]
    v_add_u32 v32, s65, v28
    v_add_u32 v40, s65, v36
    v_add_u32 v33, s65, v29
    v_add_u32 v41, s65, v37
    v_mfma_f32_32x32x16_bf16 v[128:143], v[64:67], v[76:79], v[128:143]
    s_cmp_lt_u32 s67, 8
    v_mfma_f32_32x32x16_bf16 v[144:159], v[68:71], v[64:67], v[144:159]
    s_cbranch_scc1 K_LOOP0
    v_mov_b32 v189, v188
    v_mov_b32 v193, v192
    v_mov_b32 v197, v196
    s_waitcnt lgkmcnt(0)
    v_mfma_f32_32x32x16_bf16 v[128:143], v[80:83], v[92:95], v[128:143]
    v_permlane32_swap_b32 v188, v189
    v_permlane32_swap_b32 v192, v193
    v_permlane32_swap_b32 v196, v197
    v_add_f32 v188, v188, v189
    v_add_f32 v192, v192, v193
    v_add_f32 v196, v196, v197
    ds_write_b32 v184, v188 offset:0
    ds_write_b32 v184, v192 offset:512
    ds_write_b32 v184, v196 offset:1024
    v_mfma_f32_32x32x16_bf16 v[128:143], v[96:99], v[108:111], v[128:143]
    s_waitcnt lgkmcnt(0)
    s_barrier
    v_mfma_f32_32x32x16_bf16 v[160:175], v[88:91], v[80:83], v[160:175]
    s_lshl_b32 s61, s53, 7
    s_add_u32 s61, s61, 151552
    v_lshl_add_u32 v42, v4, 2, s61
    v_lshlrev_b32 v9, 4, v3
    v_mfma_f32_32x32x16_bf16 v[160:175], v[104:107], v[96:99], v[160:175]
    v_add_u32 v9, 152576, v9
    s_lshl_b32 s61, s53, 12
    s_add_u32 s61, s61, 90112
    v_add_u32 v8, s61, v5
    v_mfma_f32_32x32x16_bf16 v[144:159], v[84:87], v[80:83], v[144:159]
    v_mov_b32 v43, 153152
    ds_write_b128 v8, v[128:131] offset:0
    ds_write_b128 v8, v[132:135] offset:1024
    ds_write_b128 v8, v[136:139] offset:2048
    ds_write_b128 v8, v[140:143] offset:3072
    v_mfma_f32_32x32x16_bf16 v[144:159], v[100:103], v[96:99], v[144:159]
    s_lshl_b32 s61, s53, 11
    s_add_u32 s62, s61, 16384
    v_add_u32 v8, s62, v5
    s_lshl_b32 s64, s58, 14
    s_add_u32 s64, s64, s61
    s_waitcnt lgkmcnt(0)
    s_barrier
    ds_read_b32 v10, v42
    ds_read_b32 v11, v42 offset:512
    ds_read_b128 v[64:67], v9 offset:128
    ds_read_b128 v[68:71], v9 offset:160
    ds_read_b128 v[72:75], v9 offset:192
    ds_read_b128 v[76:79], v9 offset:224
    ds_read_b128 v[48:51], v9 offset:0
    ds_read_b128 v[52:55], v9 offset:32
    ds_read_b128 v[56:59], v9 offset:64
    ds_read_b128 v[60:63], v9 offset:96
    ds_read_b64 v[12:13], v43
    s_waitcnt lgkmcnt(9)
    v_mul_f32 v160, v160, v10
    v_mul_f32 v161, v161, v10
    v_mul_f32 v162, v162, v10
    v_mul_f32 v163, v163, v10
    v_mul_f32 v164, v164, v10
    v_mul_f32 v165, v165, v10
    v_mul_f32 v166, v166, v10
    v_mul_f32 v167, v167, v10
    v_mul_f32 v168, v168, v10
    v_mul_f32 v169, v169, v10
    v_mul_f32 v170, v170, v10
    v_mul_f32 v171, v171, v10
    v_mul_f32 v172, v172, v10
    v_mul_f32 v173, v173, v10
    v_mul_f32 v174, v174, v10
    v_mul_f32 v175, v175, v10
    s_waitcnt lgkmcnt(5)
    v_fmac_f32 v160, v64, v11
    v_fmac_f32 v161, v65, v11
    v_fmac_f32 v162, v66, v11
    v_fmac_f32 v163, v67, v11
    v_fmac_f32 v164, v68, v11
    v_fmac_f32 v165, v69, v11
    v_fmac_f32 v166, v70, v11
    v_fmac_f32 v167, v71, v11
    v_fmac_f32 v168, v72, v11
    v_fmac_f32 v169, v73, v11
    v_fmac_f32 v170, v74, v11
    v_fmac_f32 v171, v75, v11
    v_fmac_f32 v172, v76, v11
    v_fmac_f32 v173, v77, v11
    v_fmac_f32 v174, v78, v11
    v_fmac_f32 v175, v79, v11
    v_cvt_pk_bf16_f32 v80, v160, v161
    v_cvt_pk_bf16_f32 v81, v162, v163
    v_cvt_pk_bf16_f32 v82, v164, v165
    v_cvt_pk_bf16_f32 v83, v166, v167
    v_cvt_pk_bf16_f32 v84, v168, v169
    v_cvt_pk_bf16_f32 v85, v170, v171
    v_cvt_pk_bf16_f32 v86, v172, v173
    v_cvt_pk_bf16_f32 v87, v174, v175
    buffer_store_dwordx4 v[80:83], v5, s[40:43], s64 offen sc1
    buffer_store_dwordx4 v[84:87], v5, s[40:43], s64 offen offset:1024 sc1
    v_add_u32 v112, v80, v81
    v_add3_u32 v112, v82, v83, v112
    v_add3_u32 v112, v84, v85, v112
    v_add3_u32 v112, v86, v87, v112
    ds_write_b128 v8, v[80:83]
    ds_write_b128 v8, v[84:87] offset:1024
    s_nop 1
    v_add_u32_dpp v112, v112, v112 quad_perm:[1,0,3,2] row_mask:0xf bank_mask:0xf
    s_nop 1
    v_add_u32_dpp v112, v112, v112 quad_perm:[2,3,0,1] row_mask:0xf bank_mask:0xf
    s_nop 1
    v_add_u32_dpp v112, v112, v112 row_half_mirror row_mask:0xf bank_mask:0xf
    s_nop 1
    v_add_u32_dpp v112, v112, v112 row_mirror row_mask:0xf bank_mask:0xf
    v_mov_b32 v113, v112
    s_nop 1
    v_permlane16_swap_b32 v112, v113
    s_nop 0
    v_add_u32 v112, v112, v113
    v_mov_b32 v113, v112
    s_nop 1
    v_permlane32_swap_b32 v112, v113
    s_nop 0
    v_add_u32 v112, v112, v113
    s_lshl_b32 s62, s58, 3
    s_add_u32 s62, s62, s52
    s_lshl_b32 s62, s62, 6
    s_add_u32 s62, s62, 0x880000
    s_waitcnt lgkmcnt(2)
    v_mov_b32 v114, v12
    v_mov_b32 v115, v13
    s_mov_b64 exec, 1
    buffer_store_dwordx4 v[112:115], v5, s[40:43], s62 offen sc1
    s_mov_b64 exec, -1
    v_mul_f32 v10, 0x3eb8aa3b, v10
    v_mul_f32 v11, 0x3eb8aa3b, v11
    s_waitcnt lgkmcnt(2)
    v_mul_f32 v152, v152, v10
    v_fmac_f32 v152, v56, v11
    v_mul_f32 v153, v153, v10
    v_fmac_f32 v153, v57, v11
    v_mul_f32 v154, v154, v10
    v_fmac_f32 v154, v58, v11
    v_mul_f32 v155, v155, v10
    v_fmac_f32 v155, v59, v11
    v_mul_f32 v156, v156, v10
    v_fmac_f32 v156, v60, v11
    v_mul_f32 v157, v157, v10
    v_fmac_f32 v157, v61, v11
    v_mul_f32 v158, v158, v10
    v_fmac_f32 v158, v62, v11
    v_mul_f32 v159, v159, v10
    v_fmac_f32 v159, v63, v11
    v_cvt_pk_bf16_f32 v88, v152, v153
    v_cvt_pk_bf16_f32 v89, v154, v155
    v_cvt_pk_bf16_f32 v90, v156, v157
    v_cvt_pk_bf16_f32 v91, v158, v159
    s_lshl_b32 s61, s53, 10
    s_add_u32 s61, s61, 49152
    v_add_u32 v8, s61, v5
    ds_write_b128 v8, v[88:91]
    v_mul_f32 v144, v144, v10
    v_fmac_f32 v144, v48, v11
    v_mul_f32 v145, v145, v10
    v_fmac_f32 v145, v49, v11
    v_mul_f32 v146, v146, v10
    v_fmac_f32 v146, v50, v11
    v_mul_f32 v147, v147, v10
    v_fmac_f32 v147, v51, v11
    v_mul_f32 v148, v148, v10
    v_fmac_f32 v148, v52, v11
    v_mul_f32 v149, v149, v10
    v_fmac_f32 v149, v53, v11
    v_mul_f32 v150, v150, v10
    v_fmac_f32 v150, v54, v11
    v_mul_f32 v151, v151, v10
    v_fmac_f32 v151, v55, v11
    v_cvt_pk_bf16_f32 v22, v144, v145
    v_cvt_pk_bf16_f32 v23, v146, v147
    v_cvt_pk_bf16_f32 v24, v148, v149
    v_cvt_pk_bf16_f32 v25, v150, v151
    s_branch K_PUB
K_LOOP1:
    v_mov_b32 v8, 0
    buffer_load_dwordx2 v[12:13], v8, s[44:47], 0 offen sc1
K_LOOP1T:
    s_sub_u32 s62, s67, 3
    s_cmp_lt_u32 s62, 2
    s_cbranch_scc1 K_L1_W8
    s_waitcnt vmcnt(7)
K_L1_W8:
    s_waitcnt vmcnt(8)
    s_barrier
    s_lshl_b32 s4, s3, 7
    s_mov_b32 m0, s6
    s_add_u32 s4, s4, s30
    buffer_load_dwordx4 v22, s[32:35], s4 offen offset:0 lds
    s_mul_i32 s5, s3, 196608
    s_add_u32 s61, s6, s7
    buffer_load_dwordx4 v23, s[32:35], s4 offen offset:1024 lds
    s_add_u32 s5, s5, s31
    s_add_u32 s3, s3, 1
    buffer_load_dwordx4 v24, s[32:35], s4 offen offset:2048 lds
    s_and_b32 s3, s3, 7
    s_add_u32 s6, s6, 28672
    buffer_load_dwordx4 v25, s[32:35], s4 offen offset:3072 lds
    s_mov_b32 m0, s61
    s_nop 0
    buffer_load_dwordx4 v14, s[36:39], s5 offen offset:0 lds
    s_cmp_ge_u32 s6, 143360
    s_cselect_b32 s61, 143360, 0
    s_sub_u32 s6, s6, s61
    buffer_load_dwordx4 v15, s[36:39], s5 offen offset:1024 lds
    buffer_load_dwordx4 v16, s[36:39], s5 offen offset:2048 lds
    s_cmp_lg_u32 s67, 2
    s_cbranch_scc1 K_L1_PUB
K_L1_PUB_r:
    s_cmp_lg_u32 s66, 0
    s_cbranch_scc1 K_L1_PUB
    v_readfirstlane_b32 s66, v13
    ds_read_b64 v[176:177], v43
    s_cmp_lg_u32 s66, 0
    s_cbranch_scc1 K_L1_PUB_ok
    buffer_load_dwordx2 v[12:13], v8, s[44:47], 0 offen sc1
    s_branch K_L1_PUB
K_L1_PUB_ok:
    v_mov_b32 v178, v12
    v_mov_b32 v179, v13
    s_mov_b32 s62, 0x850000
    s_mov_b32 exec_lo, 1
    s_mov_b32 exec_hi, 1
    s_waitcnt lgkmcnt(0)
    buffer_store_dwordx4 v[176:179], v184, s[40:43], s62 offen sc1
    s_mov_b64 exec, -1
K_L1_PUB:
    s_add_u32 s67, s67, 1
    s_cmp_lt_u32 s67, 6
    s_cbranch_scc1 K_LOOP1T
    s_waitcnt vmcnt(7)
    s_barrier
K_L1_PUB2_r:
    s_cmp_lg_u32 s66, 0
    s_cbranch_scc1 K_L1_PUB2
    s_waitcnt vmcnt(0)
    v_readfirstlane_b32 s66, v13
    ds_read_b64 v[176:177], v43
    s_cmp_lg_u32 s66, 0
    s_cbranch_scc1 K_L1_PUB2_ok
    buffer_load_dwordx2 v[12:13], v8, s[44:47], 0 offen sc1
    s_add_u32 s67, s67, 1
    s_cmp_lt_u32 s67, 100000
    s_cbranch_scc1 K_L1_PUB2_r
    s_branch K_L1_PUB2
K_L1_PUB2_ok:
    v_mov_b32 v178, v12
    v_mov_b32 v179, v13
    s_mov_b32 s62, 0x850000
    s_mov_b32 exec_lo, 1
    s_mov_b32 exec_hi, 1
    s_waitcnt lgkmcnt(0)
    buffer_store_dwordx4 v[176:179], v184, s[40:43], s62 offen sc1
    s_mov_b64 exec, -1
K_L1_PUB2:
    s_mov_b32 s62, 0x850000
    buffer_load_dwordx4 v[180:183], v185, s[40:43], s62 offen sc1
    buffer_load_dwordx4 v[112:115], v186, s[40:43], s62 offen sc1
    s_lshl_b32 s63, s53, 7
    s_add_u32 s63, s63, 151552
    v_lshl_add_u32 v9, v3, 5, s63
    v_lshl_add_u32 v42, v4, 2, s63
    v_mov_b32 v11, 153152
    ds_write_b64 v11, v[12:13]
    s_lshl_b32 s63, s53, 12
    s_add_u32 s63, s63, 90112
    v_add_u32 v11, s63, v5
    v_lshlrev_b32 v10, 4, v2
    v_add_u32 v10, 153600, v10
    s_mov_b32 s6, 0
    s_waitcnt vmcnt(2)
    s_barrier
K_LS_CHK:
    s_waitcnt vmcnt(0)
    v_cmp_eq_u64 vcc, v[182:183], v[12:13]
    v_cmp_eq_u64 s[68:69], v[114:115], v[12:13]
    s_and_b64 vcc, vcc, s[68:69]
    s_cmp_eq_u64 vcc, exec
    s_cbranch_scc1 K_LS_OK
    buffer_load_dwordx4 v[180:183], v185, s[40:43], s62 offen sc1
    buffer_load_dwordx4 v[112:115], v186, s[40:43], s62 offen sc1
    s_add_u32 s6, s6, 1
    s_cmp_lt_u32 s6, 100000
    s_cbranch_scc1 K_LS_CHK
K_LS_OK:
    ds_write_b32 v42, v180
    ds_write_b32 v42, v181 offset:512
    s_waitcnt lgkmcnt(0)
    ds_read_b128 v[48:51], v9 offset:0
    ds_read_b128 v[64:67], v9 offset:512
    ds_read_b128 v[52:55], v9 offset:16
    ds_read_b128 v[68:71], v9 offset:528
    ds_read_b128 v[56:59], v9 offset:64
    ds_read_b128 v[72:75], v9 offset:576
    ds_read_b128 v[60:63], v9 offset:80
    ds_read_b128 v[76:79], v9 offset:592
    s_barrier
    ds_read_b128 v[188:191], v10 offset:0
    ds_read_b128 v[192:195], v10 offset:512
    ds_read_b128 v[196:199], v10 offset:1024
    v_lshlrev_b32 v10, 2, v2
    v_add_u32 v10, 152576, v10
    s_lshl_b32 s62, s53, 11
    s_add_u32 s63, s62, 40960
    v_add_u32 v8, s63, v5
    s_lshl_b32 s63, s58, 14
    s_add_u32 s63, s63, s62
    s_add_u32 s63, s63, 8192
    s_waitcnt lgkmcnt(0)
    v_add_f32 v188, v188, v189
    v_add_f32 v190, v190, v191
    v_add_f32 v192, v192, v193
    v_add_f32 v194, v194, v195
    v_add_f32 v196, v196, v197
    v_add_f32 v198, v198, v199
    v_add_f32 v188, v188, v190
    v_add_f32 v192, v192, v194
    v_add_f32 v196, v196, v198
    ds_write_b32 v10, v188
    ds_write_b32 v10, v192 offset:128
    v_mul_f32 v64, v64, v196
    v_mul_f32 v65, v65, v196
    v_mul_f32 v66, v66, v196
    v_mul_f32 v67, v67, v196
    v_mul_f32 v68, v68, v196
    v_mul_f32 v69, v69, v196
    v_mul_f32 v70, v70, v196
    v_mul_f32 v71, v71, v196
    v_mul_f32 v72, v72, v196
    v_mul_f32 v73, v73, v196
    v_mul_f32 v74, v74, v196
    v_mul_f32 v75, v75, v196
    v_mul_f32 v76, v76, v196
    v_mul_f32 v77, v77, v196
    v_mul_f32 v78, v78, v196
    v_mul_f32 v79, v79, v196
    s_waitcnt lgkmcnt(0)
    s_barrier
    ds_read_b128 v[144:147], v11 offset:0
    ds_read_b128 v[148:151], v11 offset:1024
    ds_read_b128 v[152:155], v11 offset:2048
    ds_read_b128 v[156:159], v11 offset:3072
    s_waitcnt lgkmcnt(3)
    v_fma_f32 v144, v144, v48, v64
    v_fma_f32 v145, v145, v49, v65
    v_fma_f32 v146, v146, v50, v66
    v_fma_f32 v147, v147, v51, v67
    s_waitcnt lgkmcnt(2)
    v_fma_f32 v148, v148, v52, v68
    v_fma_f32 v149, v149, v53, v69
    v_fma_f32 v150, v150, v54, v70
    v_fma_f32 v151, v151, v55, v71
    s_waitcnt lgkmcnt(1)
    v_fma_f32 v152, v152, v56, v72
    v_fma_f32 v153, v153, v57, v73
    v_fma_f32 v154, v154, v58, v74
    v_fma_f32 v155, v155, v59, v75
    s_waitcnt lgkmcnt(0)
    v_fma_f32 v156, v156, v60, v76
    v_fma_f32 v157, v157, v61, v77
    v_fma_f32 v158, v158, v62, v78
    v_fma_f32 v159, v159, v63, v79
    v_cvt_pk_bf16_f32 v80, v144, v145
    v_cvt_pk_bf16_f32 v81, v146, v147
    v_cvt_pk_bf16_f32 v82, v148, v149
    v_cvt_pk_bf16_f32 v83, v150, v151
    v_cvt_pk_bf16_f32 v84, v152, v153
    v_cvt_pk_bf16_f32 v85, v154, v155
    v_cvt_pk_bf16_f32 v86, v156, v157
    v_cvt_pk_bf16_f32 v87, v158, v159
    buffer_store_dwordx4 v[80:83], v5, s[40:43], s63 offen sc1
    buffer_store_dwordx4 v[84:87], v5, s[40:43], s63 offen offset:1024 sc1
    v_add_u32 v112, v80, v81
    v_add3_u32 v112, v82, v83, v112
    v_add3_u32 v112, v84, v85, v112
    v_add3_u32 v112, v86, v87, v112
    ds_write_b128 v8, v[80:83]
    ds_write_b128 v8, v[84:87] offset:1024
    s_nop 1
    v_add_u32_dpp v112, v112, v112 quad_perm:[1,0,3,2] row_mask:0xf bank_mask:0xf
    s_nop 1
    v_add_u32_dpp v112, v112, v112 quad_perm:[2,3,0,1] row_mask:0xf bank_mask:0xf
    s_nop 1
    v_add_u32_dpp v112, v112, v112 row_half_mirror row_mask:0xf bank_mask:0xf
    s_nop 1
    v_add_u32_dpp v112, v112, v112 row_mirror row_mask:0xf bank_mask:0xf
    v_mov_b32 v113, v112
    s_nop 1
    v_permlane16_swap_b32 v112, v113
    s_nop 0
    v_add_u32 v112, v112, v113
    v_mov_b32 v113, v112
    s_nop 1
    v_permlane32_swap_b32 v112, v113
    s_nop 0
    v_add_u32 v112, v112, v113
    s_lshl_b32 s62, s58, 3
    s_add_u32 s62, s62, s52
    s_lshl_b32 s62, s62, 6
    s_add_u32 s62, s62, 0x880000
    s_waitcnt lgkmcnt(2)
    v_mov_b32 v114, v12
    v_mov_b32 v115, v13
    s_mov_b64 exec, 1
    buffer_store_dwordx4 v[112:115], v5, s[40:43], s62 offen sc1
    s_mov_b64 exec, -1
K_PUB:
    s_mov_b32 s7, 0
    s_mov_b32 s30, 0x0000ffff
    s_mov_b32 s31, 0x0000ffff
    v_mov_b32 v31, 0xf149f2ca
    s_lshl_b32 s61, s57, 10
    s_add_u32 s61, s61, 49152
    v_add_u32 v8, s61, v5
    s_waitcnt lgkmcnt(0)
    s_barrier
    s_cmp_eq_u32 s54, 0
    s_cbranch_scc1 K_HAVEQ
    ds_read_b128 v[22:25], v8
K_HAVEQ:
    s_cmp_ge_u32 s57, 2
    s_cbranch_scc1 K_NOP0
    s_setprio 2
K_NOP0:
    s_mov_b32 s5, 0
    s_mov_b32 s0, 0
K_CHUNK0:
    s_add_u32 s61, s57, 8
    s_mov_b32 s62, 8
    s_mov_b32 s3, s57
K_CHUNK:
    s_lshl_b32 s69, s61, 11
    s_lshl_b32 s68, s62, 11
    v_add_u32 v26, s69, v253
    ds_read_b128 v[36:39], v26
    v_add_u32 v26, s68, v253
    ds_read_b128 v[32:35], v26
    v_add_u32 v27, s69, v254
    s_mov_b64 exec, s[30:31]
    ds_read_b128 v[224:227], v27
    ds_read_b128 v[228:231], v27 offset:1024
    s_mov_b64 exec, -1
    v_add_u32 v27, s68, v254
    v_mov_b32 v30, v31
    s_mov_b32 s4, 0
    s_waitcnt lgkmcnt(3)
    v_mfma_f32_32x32x16_bf16 v[60:75], v[36:39], v[22:25], v[200:215]
    s_nop 5
K_P1:
    s_waitcnt lgkmcnt(0)
    v_mfma_f32_32x32x16_bf16 v[44:59], v[32:35], v[22:25], 0
    ds_read_b128 v[36:39], v26 offset:2048
    s_nop 2
    v_max3_f32 v30, v60, v61, v30
    v_max3_f32 v30, v62, v63, v30
    v_max3_f32 v30, v64, v65, v30
    v_max3_f32 v30, v66, v67, v30
    v_max3_f32 v30, v68, v69, v30
    v_max3_f32 v30, v70, v71, v30
    v_max3_f32 v30, v72, v73, v30
    v_max3_f32 v30, v74, v75, v30
    s_cmp_ge_u32 s4, s0
    s_cbranch_scc1 K_P1_DONE
    s_add_u32 s4, s4, 1
    s_waitcnt lgkmcnt(0)
    v_mfma_f32_32x32x16_bf16 v[60:75], v[36:39], v[22:25], 0
    v_add_u32 v26, 4096, v26
    ds_read_b128 v[32:35], v26
    v_max3_f32 v30, v44, v45, v30
    v_max3_f32 v30, v46, v47, v30
    v_max3_f32 v30, v48, v49, v30
    v_max3_f32 v30, v50, v51, v30
    v_max3_f32 v30, v52, v53, v30
    v_max3_f32 v30, v54, v55, v30
    v_max3_f32 v30, v56, v57, v30
    v_max3_f32 v30, v58, v59, v30
    s_cmp_ge_u32 s4, s0
    s_cbranch_scc1 K_P1_DONE
    s_add_u32 s4, s4, 1
    s_branch K_P1
K_P1_DONE:
    v_mov_b32 v8, v30
    s_waitcnt lgkmcnt(0)
    v_add_u32 v26, s69, v253
    ds_read_b128 v[36:39], v26
    v_permlane32_swap_b32 v30, v8
    v_add_u32 v26, s68, v253
    ds_read_b128 v[32:35], v26
    v_max_f32 v30, v30, v8
    v_sub_f32 v8, v31, v30
    v_exp_f32 v8, v8
    v_mov_b32 v31, v30
    v_sub_f32 v200, v200, v30
    v_sub_f32 v201, v201, v30
    v_sub_f32 v202, v202, v30
    v_sub_f32 v203, v203, v30
    v_sub_f32 v204, v204, v30
    v_sub_f32 v205, v205, v30
    v_sub_f32 v206, v206, v30
    v_sub_f32 v207, v207, v30
    v_sub_f32 v208, v208, v30
    v_sub_f32 v209, v209, v30
    v_sub_f32 v210, v210, v30
    v_sub_f32 v211, v211, v30
    v_sub_f32 v212, v212, v30
    v_sub_f32 v213, v213, v30
    v_sub_f32 v214, v214, v30
    v_sub_f32 v215, v215, v30
    s_waitcnt lgkmcnt(1)
    v_sub_f32 v76, 0, v30
    v_mfma_f32_32x32x16_bf16 v[60:75], v[36:39], v[22:25], v[200:215]
    v_mov_b32 v77, v76
    v_mov_b32 v78, v76
    v_mov_b32 v79, v76
    v_mov_b32 v80, v76
    v_mov_b32 v81, v76
    v_mov_b32 v82, v76
    v_mov_b32 v83, v76
    v_mov_b32 v84, v76
    v_mov_b32 v85, v76
    v_mov_b32 v86, v76
    v_mov_b32 v87, v76
    v_mov_b32 v88, v76
    v_mov_b32 v89, v76
    v_mov_b32 v90, v76
    v_mov_b32 v91, v76
    v_mul_f32 v232, v232, v8
    v_mul_f32 v233, v233, v8
    v_mul_f32 v234, v234, v8
    v_mul_f32 v235, v235, v8
    v_mul_f32 v236, v236, v8
    v_mul_f32 v237, v237, v8
    v_mul_f32 v238, v238, v8
    v_mul_f32 v239, v239, v8
    v_mul_f32 v240, v240, v8
    s_mov_b32 s4, 0
K_P2:
    s_waitcnt lgkmcnt(0)
    v_mfma_f32_32x32x16_bf16 v[44:59], v[32:35], v[22:25], v[76:91]
    ds_read_b128 v[36:39], v26 offset:2048
    s_mov_b64 exec, s[30:31]
    ds_read_b128 v[216:219], v27
    ds_read_b128 v[220:223], v27 offset:1024
    s_mov_b64 exec, -1
    v_exp_f32 v60, v60
    v_exp_f32 v61, v61
    v_exp_f32 v62, v62
    v_exp_f32 v63, v63
    v_exp_f32 v64, v64
    v_exp_f32 v65, v65
    v_exp_f32 v66, v66
    v_exp_f32 v67, v67
    v_exp_f32 v68, v68
    v_exp_f32 v69, v69
    v_exp_f32 v70, v70
    v_exp_f32 v71, v71
    v_exp_f32 v72, v72
    v_exp_f32 v73, v73
    v_exp_f32 v74, v74
    v_exp_f32 v75, v75
    v_cvt_pk_bf16_f32 v96, v60, v61
    v_cvt_pk_bf16_f32 v97, v62, v63
    v_cvt_pk_bf16_f32 v98, v64, v65
    v_cvt_pk_bf16_f32 v99, v66, v67
    v_cvt_pk_bf16_f32 v100, v68, v69
    v_cvt_pk_bf16_f32 v101, v70, v71
    v_cvt_pk_bf16_f32 v102, v72, v73
    v_cvt_pk_bf16_f32 v103, v74, v75
    s_nop 0
    v_mfma_f32_32x32x16_bf16 v[232:247], v[224:227], v[96:99], v[232:247]
    v_mfma_f32_32x32x16_bf16 v[232:247], v[228:231], v[100:103], v[232:247]
    s_cmp_ge_u32 s4, s3
    s_cbranch_scc1 K_P2_DONE
    s_add_u32 s4, s4, 1
    s_waitcnt lgkmcnt(0)
    v_mfma_f32_32x32x16_bf16 v[60:75], v[36:39], v[22:25], v[76:91]
    v_add_u32 v26, 4096, v26
    ds_read_b128 v[32:35], v26
    s_mov_b64 exec, s[30:31]
    ds_read_b128 v[224:227], v27 offset:2048
    ds_read_b128 v[228:231], v27 offset:3072
    s_mov_b64 exec, -1
    v_add_u32 v27, 4096, v27
    v_exp_f32 v44, v44
    v_exp_f32 v45, v45
    v_exp_f32 v46, v46
    v_exp_f32 v47, v47
    v_exp_f32 v48, v48
    v_exp_f32 v49, v49
    v_exp_f32 v50, v50
    v_exp_f32 v51, v51
    v_exp_f32 v52, v52
    v_exp_f32 v53, v53
    v_exp_f32 v54, v54
    v_exp_f32 v55, v55
    v_exp_f32 v56, v56
    v_exp_f32 v57, v57
    v_exp_f32 v58, v58
    v_exp_f32 v59, v59
    v_cvt_pk_bf16_f32 v96, v44, v45
    v_cvt_pk_bf16_f32 v97, v46, v47
    v_cvt_pk_bf16_f32 v98, v48, v49
    v_cvt_pk_bf16_f32 v99, v50, v51
    v_cvt_pk_bf16_f32 v100, v52, v53
    v_cvt_pk_bf16_f32 v101, v54, v55
    v_cvt_pk_bf16_f32 v102, v56, v57
    v_cvt_pk_bf16_f32 v103, v58, v59
    s_nop 0
    v_mfma_f32_32x32x16_bf16 v[232:247], v[216:219], v[96:99], v[232:247]
    v_mfma_f32_32x32x16_bf16 v[232:247], v[220:223], v[100:103], v[232:247]
    s_cmp_ge_u32 s4, s3
    s_cbranch_scc1 K_P2_DONE
    s_add_u32 s4, s4, 1
    s_branch K_P2
K_P2_DONE:
    s_waitcnt lgkmcnt(0)
    s_cmp_eq_u32 s5, 1
    s_cbranch_scc1 K_ATT_CHECK
    s_cmp_eq_u32 s5, 2
    s_cbranch_scc1 K_SLOW1
    s_cmp_eq_u32 s5, 3
    s_cbranch_scc1 K_ATT_DONE
    s_mov_b32 s11, 0
    v_lshlrev_b32 v140, 6, v1
    v_mov_b32 v136, 0
    s_cmp_ge_u32 s57, 2
    s_cbranch_scc1 K_FETCH_ISSUED
    s_cmp_le_u32 s55, s57
    s_cbranch_scc1 K_FETCH_ISSUED
    s_mov_b32 s11, 1
    s_add_u32 s61, s57, 1
    s_lshl_b32 s61, s61, 4
    s_sub_u32 s61, s58, s61
    s_lshl_b32 s61, s61, 1
    s_add_u32 s61, s61, s54
    s_lshl_b32 s1, s61, 13
    s_lshl_b32 s10, s61, 8
    s_add_u32 s10, s10, 0x880000
    s_add_u32 s62, s1, 4096
    buffer_load_dwordx4 v[104:107], v5, s[40:43], s1 offen offset:0 sc1
    buffer_load_dwordx4 v[108:111], v5, s[40:43], s1 offen offset:1024 sc1
    buffer_load_dwordx4 v[112:115], v5, s[40:43], s1 offen offset:2048 sc1
    buffer_load_dwordx4 v[116:119], v5, s[40:43], s1 offen offset:3072 sc1
    buffer_load_dwordx4 v[120:123], v5, s[40:43], s62 offen offset:0 sc1
    buffer_load_dwordx4 v[124:127], v5, s[40:43], s62 offen offset:1024 sc1
    buffer_load_dwordx4 v[128:131], v5, s[40:43], s62 offen offset:2048 sc1
    buffer_load_dwordx4 v[132:135], v5, s[40:43], s62 offen offset:3072 sc1
    s_mov_b64 exec, 0xf
    buffer_load_dwordx4 v[136:139], v140, s[40:43], s10 offen sc1
    s_mov_b64 exec, -1
K_FETCH_ISSUED:
    v_mov_b32 v42, 0xf149f2ca
    s_cmp_eq_u32 s55, 1
    s_cselect_b32 s6, 0xf149f2ca, 0
    v_add_f32 v43, s6, v76
    v_cmp_gt_i32 vcc, 0, v255
    v_cmp_gt_i32 s[68:69], 1, v255
    s_nop 0
    v_cndmask_b32 v200, v42, v43, vcc
    v_cndmask_b32 v201, v42, v43, s[68:69]
    v_cmp_gt_i32 vcc, 2, v255
    v_cmp_gt_i32 s[68:69], 3, v255
    s_nop 0
    v_cndmask_b32 v202, v42, v43, vcc
    v_cndmask_b32 v203, v42, v43, s[68:69]
    v_cmp_gt_i32 vcc, 4, v255
    v_cmp_gt_i32 s[68:69], 5, v255
    s_nop 0
    v_cndmask_b32 v204, v42, v43, vcc
    v_cndmask_b32 v205, v42, v43, s[68:69]
    v_cmp_gt_i32 vcc, 6, v255
    v_cmp_gt_i32 s[68:69], 7, v255
    s_nop 0
    v_cndmask_b32 v206, v42, v43, vcc
    v_cndmask_b32 v207, v42, v43, s[68:69]
    v_cmp_gt_i32 vcc, 16, v255
    v_cmp_gt_i32 s[68:69], 17, v255
    s_nop 0
    v_cndmask_b32 v208, v42, v43, vcc
    v_cndmask_b32 v209, v42, v43, s[68:69]
    v_cmp_gt_i32 vcc, 18, v255
    v_cmp_gt_i32 s[68:69], 19, v255
    s_nop 0
    v_cndmask_b32 v210, v42, v43, vcc
    v_cndmask_b32 v211, v42, v43, s[68:69]
    v_cmp_gt_i32 vcc, 20, v255
    v_cmp_gt_i32 s[68:69], 21, v255
    s_nop 0
    v_cndmask_b32 v212, v42, v43, vcc
    v_cndmask_b32 v213, v42, v43, s[68:69]
    v_cmp_gt_i32 vcc, 22, v255
    v_cmp_gt_i32 s[68:69], 23, v255
    s_nop 0
    v_cndmask_b32 v214, v42, v43, vcc
    v_cndmask_b32 v215, v42, v43, s[68:69]
    s_mov_b32 s48, s16
    s_mov_b32 s49, s17
    s_mov_b32 s50, 0x400
    s_mov_b32 s51, 0x20000
    s_mov_b32 s36, s12
    s_mov_b32 s37, s13
    s_mov_b32 s38, 0x80000
    s_mov_b32 s39, 0x20000
    v_lshrrev_b32 v8, 3, v1
    v_bfe_u32 v9, v1, 4, 1
    v_lshlrev_b32 v9, 2, v9
    v_and_b32 v10, 7, v1
    v_xor_b32 v10, v10, v9
    v_lshlrev_b32 v10, 4, v10
    v_lshl_add_u32 v41, v8, 10, v10
    v_add_u32 v40, 7168, v41
    s_lshl_b32 s64, s14, 7
    s_lshl_b32 s65, s52, 16
    s_add_u32 s65, s65, s64
    s_lshl_b32 s66, s52, 13
    s_add_u32 s66, s66, 86016
    s_add_u32 s62, s57, 1
    s_mov_b32 s61, s57
    s_cmp_eq_u32 s55, 1
    s_cselect_b32 s62, 4, s62
    s_cselect_b32 s61, 4, s61
    s_sub_u32 s3, 8, s62
    s_lshl_b32 s61, s61, 11
    s_lshl_b32 s62, s62, 11
    v_add_u32 v144, s61, v253
    v_add_u32 v26, s62, v253
    v_add_u32 v145, s61, v254
    v_add_u32 v27, s62, v254
    s_mov_b32 s4, 0
    s_mov_b32 s5, 1
    v_and_b32 v146, 7, v1
    v_lshlrev_b32 v146, 4, v146
    v_lshl_add_u32 v147, v7, 10, v146
    s_cmp_eq_u32 s11, 0
    s_cbranch_scc1 K_B3
    s_mul_i32 s68, s54, 24576
    s_lshl_b32 s69, s57, 13
    s_sub_u32 s68, s68, s69
    s_add_u32 s68, s68, 8192
    v_add_u32 v9, s68, v5
    s_mov_b32 s6, 0
K_KVCHK:
    s_waitcnt vmcnt(0)
    v_cmp_eq_u64 vcc, v[138:139], v[12:13]
    s_and_b32 s68, vcc_lo, 0xf
    s_cmp_eq_u32 s68, 0xf
    s_cbranch_scc0 K_KVRETRY
    ds_write_b128 v9, v[104:107] offset:0
    ds_write_b128 v9, v[108:111] offset:1024
    ds_write_b128 v9, v[112:115] offset:2048
    ds_write_b128 v9, v[116:119] offset:3072
    ds_write_b128 v9, v[120:123] offset:4096
    ds_write_b128 v9, v[124:127] offset:5120
    ds_write_b128 v9, v[128:131] offset:6144
    ds_write_b128 v9, v[132:135] offset:7168
    v_sub_u32 v8, 0, v136
    v_add3_u32 v8, v104, v105, v8
    v_add3_u32 v8, v106, v107, v8
    v_add3_u32 v8, v108, v109, v8
    v_add3_u32 v8, v110, v111, v8
    v_add3_u32 v8, v112, v113, v8
    v_add3_u32 v8, v114, v115, v8
    v_add3_u32 v8, v116, v117, v8
    v_add3_u32 v8, v118, v119, v8
    v_add3_u32 v8, v120, v121, v8
    v_add3_u32 v8, v122, v123, v8
    v_add3_u32 v8, v124, v125, v8
    v_add3_u32 v8, v126, v127, v8
    v_add3_u32 v8, v128, v129, v8
    v_add3_u32 v8, v130, v131, v8
    v_add3_u32 v8, v132, v133, v8
    v_add3_u32 v8, v134, v135, v8
    s_nop 1
    v_add_u32_dpp v8, v8, v8 quad_perm:[1,0,3,2] row_mask:0xf bank_mask:0xf
    s_nop 1
    v_add_u32_dpp v8, v8, v8 quad_perm:[2,3,0,1] row_mask:0xf bank_mask:0xf
    s_nop 1
    v_add_u32_dpp v8, v8, v8 row_half_mirror row_mask:0xf bank_mask:0xf
    s_nop 1
    v_add_u32_dpp v8, v8, v8 row_mirror row_mask:0xf bank_mask:0xf
    v_mov_b32 v11, v8
    s_nop 1
    v_permlane16_swap_b32 v8, v11
    s_nop 0
    v_add_u32 v8, v8, v11
    v_mov_b32 v11, v8
    s_nop 1
    v_permlane32_swap_b32 v8, v11
    s_nop 0
    v_add_u32 v8, v8, v11
    s_nop 0
    v_readfirstlane_b32 s68, v8
    s_cmp_eq_u32 s68, 0
    s_cbranch_scc1 K_B3W
    s_waitcnt lgkmcnt(0)
K_KVRETRY:
    s_add_u32 s62, s1, 4096
    buffer_load_dwordx4 v[104:107], v5, s[40:43], s1 offen offset:0 sc1
    buffer_load_dwordx4 v[108:111], v5, s[40:43], s1 offen offset:1024 sc1
    buffer_load_dwordx4 v[112:115], v5, s[40:43], s1 offen offset:2048 sc1
    buffer_load_dwordx4 v[116:119], v5, s[40:43], s1 offen offset:3072 sc1
    buffer_load_dwordx4 v[120:123], v5, s[40:43], s62 offen offset:0 sc1
    buffer_load_dwordx4 v[124:127], v5, s[40:43], s62 offen offset:1024 sc1
    buffer_load_dwordx4 v[128:131], v5, s[40:43], s62 offen offset:2048 sc1
    buffer_load_dwordx4 v[132:135], v5, s[40:43], s62 offen offset:3072 sc1
    s_mov_b64 exec, 0xf
    buffer_load_dwordx4 v[136:139], v140, s[40:43], s10 offen sc1
    s_mov_b64 exec, -1
    s_add_u32 s6, s6, 1
    s_cmp_lt_u32 s6, 100000
    s_cbranch_scc1 K_KVCHK
K_B3W:
    s_waitcnt lgkmcnt(0)
K_B3:
    s_barrier
    ds_read_b128 v[36:39], v144
    ds_read_b128 v[32:35], v26
    s_mov_b64 exec, s[30:31]
    ds_read_b128 v[224:227], v145
    ds_read_b128 v[228:231], v145 offset:1024
    s_mov_b64 exec, -1
    buffer_load_dwordx4 v[14:17], v147, s[32:35], s64 offen
    buffer_load_dwordx4 v[18:21], v146, s[48:51], s64 offen
    buffer_load_dwordx4 v[248:251], v5, s[48:51], 0 offen
    s_waitcnt lgkmcnt(3)
    v_mfma_f32_32x32x16_bf16 v[60:75], v[36:39], v[22:25], v[200:215]
    s_cmp_lt_u32 s57, 2
    s_cbranch_scc1 K_TOUCHED
    s_lshl_b32 s63, s54, 1
    s_add_u32 s63, s63, s57
    s_and_b32 s61, s2, 7
    s_lshr_b32 s62, s2, 3
    s_mul_i32 s62, s62, 44032
    s_cmp_eq_u32 s63, 5
    s_cbranch_scc0 K_TOUCH_F
    v_lshlrev_b32 v8, 7, v1
    s_lshr_b32 s62, s2, 3
    s_lshl_b32 s62, s62, 14
    buffer_load_dword v42, v8, s[36:39], s62 offen
    s_add_u32 s62, s62, 8192
    buffer_load_dword v43, v8, s[36:39], s62 offen
    s_branch K_TOUCHED
K_TOUCH_F:
    s_cmp_eq_u32 s63, 4
    s_cbranch_scc1 K_TOUCH_D
    s_cmp_eq_u32 s63, 2
    s_cselect_b32 s44, s18, s20
    s_cselect_b32 s45, s19, s21
    s_mov_b32 s46, 1409024
    s_mov_b32 s47, 0x20000
    v_lshrrev_b32 v8, 2, v1
    v_mul_u32_u24 v8, 2752, v8
    v_and_b32 v9, 3, v1
    v_lshlrev_b32 v9, 7, v9
    v_min_u32 v9, 348, v9
    v_add_u32 v10, v9, v8
    s_mul_i32 s61, s61, 352
    s_add_u32 s61, s61, s62
    buffer_load_dword v42, v10, s[44:47], s61 offen
    s_branch K_TOUCHED
K_TOUCH_D:
    s_mov_b32 s44, s22
    s_mov_b32 s45, s23
    s_mov_b32 s46, 0x158000
    s_mov_b32 s47, 0x20000
    v_min_u32 v8, 42, v1
    v_lshlrev_b32 v8, 10, v8
    s_lshl_b32 s61, s61, 7
    s_add_u32 s61, s61, s62
    buffer_load_dword v42, v8, s[44:47], s61 offen
K_TOUCHED:
    s_cmp_eq_u32 s55, 0
    s_cbranch_scc1 K_ATT_CHECK
    s_nop 0
    s_branch K_P2
K_SLOW1:
    s_cmp_eq_u32 s55, 0
    s_cbranch_scc1 K_ATT_DONE
    v_mov_b32 v42, 0xf149f2ca
    s_cmp_eq_u32 s55, 1
    s_cselect_b32 s6, 0xf149f2ca, 0
    v_mov_b32 v43, s6
    v_cmp_gt_i32 vcc, 0, v255
    v_cmp_gt_i32 s[68:69], 1, v255
    s_nop 0
    v_cndmask_b32 v200, v42, v43, vcc
    v_cndmask_b32 v201, v42, v43, s[68:69]
    v_cmp_gt_i32 vcc, 2, v255
    v_cmp_gt_i32 s[68:69], 3, v255
    s_nop 0
    v_cndmask_b32 v202, v42, v43, vcc
    v_cndmask_b32 v203, v42, v43, s[68:69]
    v_cmp_gt_i32 vcc, 4, v255
    v_cmp_gt_i32 s[68:69], 5, v255
    s_nop 0
    v_cndmask_b32 v204, v42, v43, vcc
    v_cndmask_b32 v205, v42, v43, s[68:69]
    v_cmp_gt_i32 vcc, 6, v255
    v_cmp_gt_i32 s[68:69], 7, v255
    s_nop 0
    v_cndmask_b32 v206, v42, v43, vcc
    v_cndmask_b32 v207, v42, v43, s[68:69]
    v_cmp_gt_i32 vcc, 16, v255
    v_cmp_gt_i32 s[68:69], 17, v255
    s_nop 0
    v_cndmask_b32 v208, v42, v43, vcc
    v_cndmask_b32 v209, v42, v43, s[68:69]
    v_cmp_gt_i32 vcc, 18, v255
    v_cmp_gt_i32 s[68:69], 19, v255
    s_nop 0
    v_cndmask_b32 v210, v42, v43, vcc
    v_cndmask_b32 v211, v42, v43, s[68:69]
    v_cmp_gt_i32 vcc, 20, v255
    v_cmp_gt_i32 s[68:69], 21, v255
    s_nop 0
    v_cndmask_b32 v212, v42, v43, vcc
    v_cndmask_b32 v213, v42, v43, s[68:69]
    v_cmp_gt_i32 vcc, 22, v255
    v_cmp_gt_i32 s[68:69], 23, v255
    s_nop 0
    v_cndmask_b32 v214, v42, v43, vcc
    v_cndmask_b32 v215, v42, v43, s[68:69]
    s_mov_b32 s5, 3
    s_add_u32 s62, s57, 1
    s_mov_b32 s61, s57
    s_cmp_eq_u32 s55, 1
    s_cselect_b32 s62, 4, s62
    s_cselect_b32 s61, 4, s61
    s_sub_u32 s3, 8, s62
    s_mov_b32 s0, s3
    s_branch K_CHUNK
K_ATT_CHECK:
    s_waitcnt lgkmcnt(0)
    s_lshl_b32 s61, s55, 2
    s_add_u32 s61, s61, s57
    s_lshl_b32 s61, s61, 5
    s_lshl_b32 s62, s56, 1
    s_add_u32 s61, s61, s62
    s_add_u32 s61, s61, s54
    s_lshl_b32 s62, s61, 10
    s_add_u32 s62, s62, 0x400000
    s_lshl_b32 s61, s61, 6
    s_add_u32 s61, s61, 0x8a0000
    v_cmp_gt_f32 vcc, 0x5d800000, v240
    s_cmp_eq_u64 vcc, exec
    s_cbranch_scc1 K_ATT_DONE2
    s_waitcnt vmcnt(0)
    v_mov_b32 v42, 0xf149f2ca
    v_mov_b32 v43, 0
    v_cmp_le_i32 vcc, 0, v255
    v_cmp_le_i32 s[68:69], 1, v255
    s_nop 0
    v_cndmask_b32 v200, v42, v43, vcc
    v_cndmask_b32 v201, v42, v43, s[68:69]
    v_cmp_le_i32 vcc, 2, v255
    v_cmp_le_i32 s[68:69], 3, v255
    s_nop 0
    v_cndmask_b32 v202, v42, v43, vcc
    v_cndmask_b32 v203, v42, v43, s[68:69]
    v_cmp_le_i32 vcc, 4, v255
    v_cmp_le_i32 s[68:69], 5, v255
    s_nop 0
    v_cndmask_b32 v204, v42, v43, vcc
    v_cndmask_b32 v205, v42, v43, s[68:69]
    v_cmp_le_i32 vcc, 6, v255
    v_cmp_le_i32 s[68:69], 7, v255
    s_nop 0
    v_cndmask_b32 v206, v42, v43, vcc
    v_cndmask_b32 v207, v42, v43, s[68:69]
    v_cmp_le_i32 vcc, 16, v255
    v_cmp_le_i32 s[68:69], 17, v255
    s_nop 0
    v_cndmask_b32 v208, v42, v43, vcc
    v_cndmask_b32 v209, v42, v43, s[68:69]
    v_cmp_le_i32 vcc, 18, v255
    v_cmp_le_i32 s[68:69], 19, v255
    s_nop 0
    v_cndmask_b32 v210, v42, v43, vcc
    v_cndmask_b32 v211, v42, v43, s[68:69]
    v_cmp_le_i32 vcc, 20, v255
    v_cmp_le_i32 s[68:69], 21, v255
    s_nop 0
    v_cndmask_b32 v212, v42, v43, vcc
    v_cndmask_b32 v213, v42, v43, s[68:69]
    v_cmp_le_i32 vcc, 22, v255
    v_cmp_le_i32 s[68:69], 23, v255
    s_nop 0
    v_cndmask_b32 v214, v42, v43, vcc
    v_cndmask_b32 v215, v42, v43, s[68:69]
    v_mov_b32 v232, 0
    v_mov_b32 v233, 0
    v_mov_b32 v234, 0
    v_mov_b32 v235, 0
    v_mov_b32 v236, 0
    v_mov_b32 v237, 0
    v_mov_b32 v238, 0
    v_mov_b32 v239, 0
    v_mov_b32 v240, 0
    v_mov_b32 v241, 0
    v_mov_b32 v242, 0
    v_mov_b32 v243, 0
    v_mov_b32 v244, 0
    v_mov_b32 v245, 0
    v_mov_b32 v246, 0
    v_mov_b32 v247, 0
    v_mov_b32 v31, 0xf149f2ca
    s_mov_b32 s5, 2
    s_mov_b32 s0, s57
    s_branch K_CHUNK0
K_ATT_DONE:
    s_lshl_b32 s61, s55, 2
    s_add_u32 s61, s61, s57
    s_lshl_b32 s61, s61, 5
    s_lshl_b32 s62, s56, 1
    s_add_u32 s61, s61, s62
    s_add_u32 s61, s61, s54
    s_lshl_b32 s62, s61, 10
    s_add_u32 s62, s62, 0x400000
    s_lshl_b32 s61, s61, 6
    s_add_u32 s61, s61, 0x8a0000
    s_nop 1
K_ATT_DONE2:
    v_rcp_f32 v8, v240
    s_nop 0
    v_mul_f32 v232, v232, v8
    v_mul_f32 v233, v233, v8
    v_mul_f32 v234, v234, v8
    v_mul_f32 v235, v235, v8
    v_mul_f32 v236, v236, v8
    v_mul_f32 v237, v237, v8
    v_mul_f32 v238, v238, v8
    v_mul_f32 v239, v239, v8
    v_cvt_pk_bf16_f32 v96, v232, v233
    v_cvt_pk_bf16_f32 v97, v234, v235
    v_cvt_pk_bf16_f32 v98, v236, v237
    v_cvt_pk_bf16_f32 v99, v238, v239
    buffer_store_dwordx4 v[96:99], v5, s[40:43], s62 offen sc1
    v_add_u32 v100, v96, v97
    v_add3_u32 v100, v98, v99, v100
    s_nop 1
    v_add_u32_dpp v100, v100, v100 quad_perm:[1,0,3,2] row_mask:0xf bank_mask:0xf
    s_nop 1
    v_add_u32_dpp v100, v100, v100 quad_perm:[2,3,0,1] row_mask:0xf bank_mask:0xf
    s_nop 1
    v_add_u32_dpp v100, v100, v100 row_half_mirror row_mask:0xf bank_mask:0xf
    s_nop 1
    v_add_u32_dpp v100, v100, v100 row_mirror row_mask:0xf bank_mask:0xf
    v_mov_b32 v101, v100
    s_nop 1
    v_permlane16_swap_b32 v100, v101
    s_nop 0
    v_add_u32 v100, v100, v101
    v_mov_b32 v101, v100
    s_nop 1
    v_permlane32_swap_b32 v100, v101
    s_nop 0
    v_add_u32 v100, v100, v101
    v_mov_b32 v102, v12
    v_mov_b32 v103, v13
    s_mov_b64 exec, 1
    buffer_store_dwordx4 v[100:103], v5, s[40:43], s61 offen sc1
    s_mov_b64 exec, -1
    s_setprio 0
    s_lshl_b32 s61, s15, 1
    s_add_u32 s61, s61, s54
    s_lshl_b32 s61, s61, 2
    s_add_u32 s61, s61, s53
    s_lshl_b32 s64, s61, 9
    s_add_u32 s64, s64, 0x8a0000
    s_lshl_b32 s61, s61, 13
    s_add_u32 s61, s61, 0x400000
    s_add_u32 s62, s61, 4096
    v_lshlrev_b32 v8, 6, v1
    v_mov_b32 v172, 0
    s_barrier
    s_mov_b64 exec, 0xff
    buffer_load_dwordx4 v[172:175], v8, s[40:43], s64 offen sc1
    s_mov_b64 exec, -1
    s_mov_b32 m0, s66
    s_add_u32 s66, s66, 2048
    buffer_load_dwordx4 v41, s[36:39], s65 offen lds
    buffer_load_dwordx4 v40, s[36:39], s65 offen offset:1024 lds
    s_add_u32 s65, s65, 16384
    s_mov_b32 m0, s66
    s_add_u32 s66, s66, 2048
    buffer_load_dwordx4 v41, s[36:39], s65 offen lds
    buffer_load_dwordx4 v40, s[36:39], s65 offen offset:1024 lds
    s_add_u32 s65, s65, 16384
    s_mov_b32 m0, s66
    s_add_u32 s66, s66, 2048
    buffer_load_dwordx4 v41, s[36:39], s65 offen lds
    buffer_load_dwordx4 v40, s[36:39], s65 offen offset:1024 lds
    s_add_u32 s65, s65, 16384
    s_mov_b32 m0, s66
    s_add_u32 s66, s66, 2048
    buffer_load_dwordx4 v41, s[36:39], s65 offen lds
    buffer_load_dwordx4 v40, s[36:39], s65 offen offset:1024 lds
    s_add_u32 s65, s65, 16384
    v_bfe_u32 v9, v1, 2, 2
    v_lshl_add_u32 v10, v3, 3, v9
    s_lshl_b32 s63, s53, 14
    s_add_u32 s63, s63, 86016
    v_lshl_add_u32 v26, v10, 7, s63
    v_lshrrev_b32 v9, 1, v9
    v_lshl_add_u32 v26, v9, 6, v26
    v_bfe_u32 v9, v1, 4, 1
    v_lshl_add_u32 v26, v9, 5, v26
    v_and_b32 v9, 3, v1
    v_lshl_add_u32 v26, v9, 3, v26
    v_xor_b32 v27, 64, v26
    v_and_b32 v10, 15, v2
    v_xor_b32 v10, v10, v3
    v_lshlrev_b32 v10, 4, v10
    s_lshl_b32 s63, s52, 13
    s_add_u32 s63, s63, 86016
    v_lshl_add_u32 v9, v2, 8, s63
    v_xor_b32 v28, 0, v10
    v_add_u32 v28, v28, v9
    v_xor_b32 v29, 32, v10
    v_add_u32 v29, v29, v9
    v_xor_b32 v30, 64, v10
    v_add_u32 v30, v30, v9
    v_xor_b32 v31, 96, v10
    v_add_u32 v31, v31, v9
    v_xor_b32 v32, 128, v10
    v_add_u32 v32, v32, v9
    v_xor_b32 v33, 160, v10
    v_add_u32 v33, v33, v9
    v_xor_b32 v34, 192, v10
    v_add_u32 v34, v34, v9
    v_xor_b32 v35, 224, v10
    v_add_u32 v35, v35, v9
    v_lshrrev_b32 v11, 3, v1
    s_lshl_b32 s63, s53, 3
    v_add_u32 v11, s63, v11
    v_and_b32 v9, 7, v1
    v_lshlrev_b32 v9, 1, v9
    v_and_b32 v10, 15, v11
    v_xor_b32 v9, v9, v10
    v_lshlrev_b32 v9, 4, v9
    s_lshl_b32 s63, s54, 15
    s_add_u32 s63, s63, 86016
    v_lshl_add_u32 v11, v11, 8, s63
    v_add_u32 v10, v11, v9
    v_xor_b32 v9, 16, v9
    v_add_u32 v11, v11, v9
    s_mov_b32 s6, 0
    s_mov_b64 exec, 0xff
    s_waitcnt vmcnt(8)
    s_branch K_POLLO1
K_POLLO:
    s_waitcnt vmcnt(0)
K_POLLO1:
    v_cmp_eq_u64 vcc, v[174:175], v[12:13]
    s_cmp_eq_u64 vcc, exec
    s_cbranch_scc1 K_POLLO_OK
    buffer_load_dwordx4 v[172:175], v8, s[40:43], s64 offen sc1
    s_add_u32 s6, s6, 1
    s_cmp_lt_u32 s6, 100000
    s_cbranch_scc1 K_POLLO
K_POLLO_OK:
    s_mov_b64 exec, -1
    buffer_load_dwordx4 v[44:47], v5, s[40:43], s61 offen offset:0 sc1
    buffer_load_dwordx4 v[48:51], v5, s[40:43], s61 offen offset:1024 sc1
    buffer_load_dwordx4 v[52:55], v5, s[40:43], s61 offen offset:2048 sc1
    buffer_load_dwordx4 v[56:59], v5, s[40:43], s61 offen offset:3072 sc1
    buffer_load_dwordx4 v[60:63], v5, s[40:43], s62 offen offset:0 sc1
    buffer_load_dwordx4 v[64:67], v5, s[40:43], s62 offen offset:1024 sc1
    buffer_load_dwordx4 v[68:71], v5, s[40:43], s62 offen offset:2048 sc1
    buffer_load_dwordx4 v[72:75], v5, s[40:43], s62 offen offset:3072 sc1
    s_waitcnt vmcnt(8)
    s_barrier
    ds_read_b64_tr_b16 v[108:109], v26 offset:0
    ds_read_b64_tr_b16 v[110:111], v26 offset:512
    ds_read_b64_tr_b16 v[112:113], v27 offset:0
    ds_read_b64_tr_b16 v[114:115], v27 offset:512
    ds_read_b64_tr_b16 v[116:117], v26 offset:2048
    ds_read_b64_tr_b16 v[118:119], v26 offset:2560
    ds_read_b64_tr_b16 v[120:121], v27 offset:2048
    ds_read_b64_tr_b16 v[122:123], v27 offset:2560
    ds_read_b64_tr_b16 v[124:125], v26 offset:4096
    ds_read_b64_tr_b16 v[126:127], v26 offset:4608
    ds_read_b64_tr_b16 v[128:129], v27 offset:4096
    ds_read_b64_tr_b16 v[130:131], v27 offset:4608
    ds_read_b64_tr_b16 v[132:133], v26 offset:6144
    ds_read_b64_tr_b16 v[134:135], v26 offset:6656
    ds_read_b64_tr_b16 v[136:137], v27 offset:6144
    ds_read_b64_tr_b16 v[138:139], v27 offset:6656
    ds_read_b64_tr_b16 v[140:141], v26 offset:8192
    ds_read_b64_tr_b16 v[142:143], v26 offset:8704
    ds_read_b64_tr_b16 v[144:145], v27 offset:8192
    ds_read_b64_tr_b16 v[146:147], v27 offset:8704
    ds_read_b64_tr_b16 v[148:149], v26 offset:10240
    ds_read_b64_tr_b16 v[150:151], v26 offset:10752
    ds_read_b64_tr_b16 v[152:153], v27 offset:10240
    ds_read_b64_tr_b16 v[154:155], v27 offset:10752
    ds_read_b64_tr_b16 v[156:157], v26 offset:12288
    ds_read_b64_tr_b16 v[158:159], v26 offset:12800
    ds_read_b64_tr_b16 v[160:161], v27 offset:12288
    ds_read_b64_tr_b16 v[162:163], v27 offset:12800
    ds_read_b64_tr_b16 v[164:165], v26 offset:14336
    ds_read_b64_tr_b16 v[166:167], v26 offset:14848
    ds_read_b64_tr_b16 v[168:169], v27 offset:14336
    ds_read_b64_tr_b16 v[170:171], v27 offset:14848
    s_branch K_OMM
K_OLOAD:
    buffer_load_dwordx4 v[44:47], v5, s[40:43], s61 offen offset:0 sc1
    buffer_load_dwordx4 v[48:51], v5, s[40:43], s61 offen offset:1024 sc1
    buffer_load_dwordx4 v[52:55], v5, s[40:43], s61 offen offset:2048 sc1
    buffer_load_dwordx4 v[56:59], v5, s[40:43], s61 offen offset:3072 sc1
    buffer_load_dwordx4 v[60:63], v5, s[40:43], s62 offen offset:0 sc1
    buffer_load_dwordx4 v[64:67], v5, s[40:43], s62 offen offset:1024 sc1
    buffer_load_dwordx4 v[68:71], v5, s[40:43], s62 offen offset:2048 sc1
    buffer_load_dwordx4 v[72:75], v5, s[40:43], s62 offen offset:3072 sc1
K_OMM:
    v_sub_u32 v40, 0, v172
    s_waitcnt lgkmcnt(0)
    s_waitcnt vmcnt(7)
    v_mfma_f32_32x32x16_bf16 v[76:91], v[108:111], v[44:47], 0
    v_add3_u32 v40, v44, v45, v40
    v_mfma_f32_32x32x16_bf16 v[92:107], v[112:115], v[44:47], 0
    v_add3_u32 v40, v46, v47, v40
    s_waitcnt vmcnt(6)
    v_mfma_f32_32x32x16_bf16 v[76:91], v[116:119], v[48:51], v[76:91]
    v_add3_u32 v40, v48, v49, v40
    v_mfma_f32_32x32x16_bf16 v[92:107], v[120:123], v[48:51], v[92:107]
    v_add3_u32 v40, v50, v51, v40
    s_waitcnt vmcnt(5)
    v_mfma_f32_32x32x16_bf16 v[76:91], v[124:127], v[52:55], v[76:91]
    v_add3_u32 v40, v52, v53, v40
    v_mfma_f32_32x32x16_bf16 v[92:107], v[128:131], v[52:55], v[92:107]
    v_add3_u32 v40, v54, v55, v40
    s_waitcnt vmcnt(4)
    v_mfma_f32_32x32x16_bf16 v[76:91], v[132:135], v[56:59], v[76:91]
    v_add3_u32 v40, v56, v57, v40
    v_mfma_f32_32x32x16_bf16 v[92:107], v[136:139], v[56:59], v[92:107]
    v_add3_u32 v40, v58, v59, v40
    s_waitcnt vmcnt(3)
    v_mfma_f32_32x32x16_bf16 v[76:91], v[140:143], v[60:63], v[76:91]
    v_add3_u32 v40, v60, v61, v40
    v_mfma_f32_32x32x16_bf16 v[92:107], v[144:147], v[60:63], v[92:107]
    v_add3_u32 v40, v62, v63, v40
    s_waitcnt vmcnt(2)
    v_mfma_f32_32x32x16_bf16 v[76:91], v[148:151], v[64:67], v[76:91]
    v_add3_u32 v40, v64, v65, v40
    v_mfma_f32_32x32x16_bf16 v[92:107], v[152:155], v[64:67], v[92:107]
    v_add3_u32 v40, v66, v67, v40
    s_waitcnt vmcnt(1)
    v_mfma_f32_32x32x16_bf16 v[76:91], v[156:159], v[68:71], v[76:91]
    v_add3_u32 v40, v68, v69, v40
    v_mfma_f32_32x32x16_bf16 v[92:107], v[160:163], v[68:71], v[92:107]
    v_add3_u32 v40, v70, v71, v40
    s_waitcnt vmcnt(0)
    v_mfma_f32_32x32x16_bf16 v[76:91], v[164:167], v[72:75], v[76:91]
    v_add3_u32 v40, v72, v73, v40
    v_mfma_f32_32x32x16_bf16 v[92:107], v[168:171], v[72:75], v[92:107]
    v_add3_u32 v40, v74, v75, v40
    s_nop 1
    v_add_u32_dpp v40, v40, v40 quad_perm:[1,0,3,2] row_mask:0xf bank_mask:0xf
    s_nop 1
    v_add_u32_dpp v40, v40, v40 quad_perm:[2,3,0,1] row_mask:0xf bank_mask:0xf
    s_nop 1
    v_add_u32_dpp v40, v40, v40 row_half_mirror row_mask:0xf bank_mask:0xf
    s_nop 1
    v_add_u32_dpp v40, v40, v40 row_mirror row_mask:0xf bank_mask:0xf
    v_mov_b32 v9, v40
    s_nop 1
    v_permlane16_swap_b32 v40, v9
    s_nop 0
    v_add_u32 v40, v40, v9
    v_mov_b32 v9, v40
    s_nop 1
    v_permlane32_swap_b32 v40, v9
    s_nop 0
    v_add_u32 v40, v40, v9
    s_nop 0
    v_readfirstlane_b32 s68, v40
    s_cmp_eq_u32 s68, 0
    s_cbranch_scc1 K_OOK
    s_add_u32 s6, s6, 1
    s_cmp_lt_u32 s6, 100000
    s_cbranch_scc1 K_OLOAD
K_OOK:
    s_barrier
    v_and_b32 v8, 7, v1
    v_lshlrev_b32 v9, 4, v8
    v_lshl_add_u32 v9, v7, 10, v9
    s_lshl_b32 s64, s14, 7
    s_add_u32 s61, s64, 0x600000
    s_nop 1
    ds_write_b128 v28, v[76:79]
    ds_write_b128 v29, v[80:83]
    ds_write_b128 v30, v[84:87]
    ds_write_b128 v31, v[88:91]
    ds_write_b128 v32, v[92:95]
    ds_write_b128 v33, v[96:99]
    ds_write_b128 v34, v[100:103]
    ds_write_b128 v35, v[104:107]
    v_lshrrev_b32 v41, 3, v1
    v_lshlrev_b32 v40, 4, v41
    v_lshl_add_u32 v41, v8, 10, v40
    s_lshl_b32 s62, s15, 13
    s_lshl_b32 s63, s52, 7
    s_add_u32 s62, s62, s63
    s_add_u32 s62, s62, 0x800000
    s_lshl_b32 s63, s14, 10
    s_add_u32 s63, s63, s62
    s_waitcnt lgkmcnt(0)
    s_barrier
    ds_read_b128 v[44:47], v10 offset:0
    ds_read_b128 v[48:51], v11 offset:0
    ds_read_b128 v[52:55], v10 offset:8192
    ds_read_b128 v[56:59], v11 offset:8192
    ds_read_b128 v[60:63], v10 offset:16384
    ds_read_b128 v[64:67], v11 offset:16384
    ds_read_b128 v[68:71], v10 offset:24576
    ds_read_b128 v[72:75], v11 offset:24576
    v_lshlrev_b32 v76, 16, v14
    v_and_b32 v77, 0xffff0000, v14
    v_lshlrev_b32 v78, 16, v15
    v_and_b32 v79, 0xffff0000, v15
    v_lshlrev_b32 v80, 16, v16
    v_and_b32 v81, 0xffff0000, v16
    v_lshlrev_b32 v82, 16, v17
    v_and_b32 v83, 0xffff0000, v17
    s_waitcnt lgkmcnt(6)
    v_add_f32 v44, v44, v76
    v_add_f32 v45, v45, v77
    v_add_f32 v46, v46, v78
    v_add_f32 v47, v47, v79
    v_add_f32 v48, v48, v80
    v_add_f32 v49, v49, v81
    v_add_f32 v50, v50, v82
    v_add_f32 v51, v51, v83
    s_waitcnt lgkmcnt(0)
    v_add_f32 v44, v44, v52
    v_add_f32 v60, v60, v68
    v_add_f32 v45, v45, v53
    v_add_f32 v61, v61, v69
    v_add_f32 v46, v46, v54
    v_add_f32 v62, v62, v70
    v_add_f32 v47, v47, v55
    v_add_f32 v63, v63, v71
    v_add_f32 v48, v48, v56
    v_add_f32 v64, v64, v72
    v_add_f32 v49, v49, v57
    v_add_f32 v65, v65, v73
    v_add_f32 v50, v50, v58
    v_add_f32 v66, v66, v74
    v_add_f32 v51, v51, v59
    v_add_f32 v67, v67, v75
    v_add_f32 v44, v44, v60
    v_add_f32 v45, v45, v61
    v_add_f32 v46, v46, v62
    v_add_f32 v47, v47, v63
    v_add_f32 v48, v48, v64
    v_add_f32 v49, v49, v65
    v_add_f32 v50, v50, v66
    v_add_f32 v51, v51, v67
    v_cvt_pk_bf16_f32 v36, v44, v45
    v_cvt_pk_bf16_f32 v37, v46, v47
    v_cvt_pk_bf16_f32 v38, v48, v49
    v_cvt_pk_bf16_f32 v39, v50, v51
    v_dot2_f32_bf16 v60, v36, v6, 0
    v_dot2_f32_bf16 v61, v36, v36, 0
    v_dot2_f32_bf16 v62, v36, v18, 0
    v_dot2_f32_bf16 v60, v37, v6, v60
    v_dot2_f32_bf16 v61, v37, v37, v61
    v_dot2_f32_bf16 v62, v37, v19, v62
    v_dot2_f32_bf16 v60, v38, v6, v60
    v_dot2_f32_bf16 v61, v38, v38, v61
    v_dot2_f32_bf16 v62, v38, v20, v62
    v_dot2_f32_bf16 v60, v39, v6, v60
    v_dot2_f32_bf16 v61, v39, v39, v61
    v_dot2_f32_bf16 v62, v39, v21, v62
    v_add_u32 v63, v36, v37
    v_add3_u32 v63, v38, v39, v63
    buffer_store_dwordx4 v[36:39], v9, s[40:43], s61 offen sc1
    v_add_f32_dpp v60, v60, v60 quad_perm:[1,0,3,2] row_mask:0xf bank_mask:0xf
    v_add_f32_dpp v61, v61, v61 quad_perm:[1,0,3,2] row_mask:0xf bank_mask:0xf
    v_add_f32_dpp v62, v62, v62 quad_perm:[1,0,3,2] row_mask:0xf bank_mask:0xf
    v_add_u32_dpp v63, v63, v63 quad_perm:[1,0,3,2] row_mask:0xf bank_mask:0xf
    v_add_f32_dpp v60, v60, v60 quad_perm:[2,3,0,1] row_mask:0xf bank_mask:0xf
    v_add_f32_dpp v61, v61, v61 quad_perm:[2,3,0,1] row_mask:0xf bank_mask:0xf
    v_add_f32_dpp v62, v62, v62 quad_perm:[2,3,0,1] row_mask:0xf bank_mask:0xf
    v_add_u32_dpp v63, v63, v63 quad_perm:[2,3,0,1] row_mask:0xf bank_mask:0xf
    v_add_f32_dpp v60, v60, v60 row_half_mirror row_mask:0xf bank_mask:0xf
    v_add_f32_dpp v61, v61, v61 row_half_mirror row_mask:0xf bank_mask:0xf
    v_add_f32_dpp v62, v62, v62 row_half_mirror row_mask:0xf bank_mask:0xf
    v_add_u32_dpp v63, v63, v63 row_half_mirror row_mask:0xf bank_mask:0xf
    v_min_u32 v60, -2, v60
    v_min_u32 v61, -2, v61
    v_min_u32 v62, -2, v62
    v_min_u32 v63, -2, v63
    s_mov_b32 exec_lo, 0x01010101
    s_mov_b32 exec_hi, 0x01010101
    s_add_u32 s68, s63, 0xc0000
    buffer_store_dwordx4 v[60:63], v40, s[40:43], s68 offen
    buffer_store_dwordx4 v[60:63], v40, s[40:43], s63 offen sc1
    s_mov_b64 exec, -1
    s_add_u32 s63, s62, 0xc0000
    v_mov_b32 v44, v60
    v_mov_b32 v45, v61
    v_mov_b32 v46, v62
    s_lshl_b32 s30, 0x01010101, s14
    s_not_b32 s30, s30
    s_mov_b32 s31, s30
    s_mov_b32 s36, s24
    s_mov_b32 s37, s25
    s_mov_b32 s38, 0x200000
    s_mov_b32 s39, 0x20000
    v_dot2_f32_bf16 v252, v248, v6, 0
    v_dot2_f32_bf16 v252, v249, v6, v252
    v_dot2_f32_bf16 v252, v250, v6, v252
    v_dot2_f32_bf16 v252, v251, v6, v252
    s_nop 2
    v_add_f32_dpp v252, v252, v252 quad_perm:[1,0,3,2] row_mask:0xf bank_mask:0xf
    s_nop 1
    v_add_f32_dpp v252, v252, v252 quad_perm:[2,3,0,1] row_mask:0xf bank_mask:0xf
    s_nop 1
    v_add_f32_dpp v252, v252, v252 row_half_mirror row_mask:0xf bank_mask:0xf
    s_nop 1
    v_add_f32_dpp v252, v252, v252 row_mirror row_mask:0xf bank_mask:0xf
    s_nop 1
    v_mov_b32 v8, v252
    s_nop 1
    v_permlane16_swap_b32 v252, v8
    s_nop 0
    v_add_f32 v252, v252, v8
    v_mov_b32 v8, v252
    s_nop 1
    v_permlane32_swap_b32 v252, v8
    s_nop 0
    v_add_f32 v252, v252, v8
    s_cmp_eq_u32 s59, 0
    s_cbranch_scc1 K_NOFA
    v_mov_b32 v80, v6
    v_mov_b32 v81, v6
    v_mov_b32 v82, v6
    v_mov_b32 v83, v6
    v_mov_b32 v84, v6
    v_mov_b32 v85, v6
    v_mov_b32 v86, v6
    v_mov_b32 v87, v6
    v_mov_b32 v88, v6
    v_mov_b32 v89, v6
    v_mov_b32 v90, v6
    v_mov_b32 v91, v6
    v_mov_b32 v92, v6
    v_mov_b32 v93, v6
    v_mov_b32 v94, v6
    v_mov_b32 v95, v6
    v_mov_b32 v96, v6
    v_mov_b32 v97, v6
    v_mov_b32 v98, v6
    v_mov_b32 v99, v6
    v_mov_b32 v100, v6
    v_mov_b32 v101, v6
    v_mov_b32 v102, v6
    v_mov_b32 v103, v6
K_NOFA:
    v_lshlrev_b32 v64, 16, v36
    v_and_b32 v65, 0xffff0000, v36
    v_lshlrev_b32 v66, 16, v37
    v_and_b32 v67, 0xffff0000, v37
    v_lshlrev_b32 v68, 16, v38
    v_and_b32 v69, 0xffff0000, v38
    v_lshlrev_b32 v70, 16, v39
    v_and_b32 v71, 0xffff0000, v39
    v_sub_u32 v8, 2047, v7
    s_lshl_b32 s68, s52, 3
    s_add_u32 s68, s68, 155648
    v_mov_b32 v11, s68
    s_mov_b32 s66, 0xfffff800
    v_mov_b32 v59, 0
    s_mov_b32 s6, 0
    s_mov_b64 exec, s[30:31]
K_POLL1:
    s_and_b32 s68, s6, 3
    s_cmp_eq_u32 s68, 3
    s_cselect_b32 s68, s62, s63
    buffer_load_dwordx4 v[44:47], v41, s[40:43], s68 offen sc1
    s_waitcnt vmcnt(0)
    v_max_u32 v10, v44, v45
    v_max3_u32 v10, v46, v47, v10
    v_cmp_eq_u32 vcc, -1, v10
    s_cmp_eq_u64 vcc, 0
    s_cbranch_scc1 K_POLL1_OK
    s_mov_b64 exec, vcc
    s_add_u32 s6, s6, 1
    s_cmp_lt_u32 s6, 100000
    s_cbranch_scc1 K_POLL1
K_POLL1_OK:
    s_mov_b64 exec, -1
    v_add_f32_dpp v44, v44, v44 quad_perm:[1,0,3,2] row_mask:0xf bank_mask:0xf
    v_add_f32_dpp v45, v45, v45 quad_perm:[1,0,3,2] row_mask:0xf bank_mask:0xf
    v_add_f32_dpp v46, v46, v46 quad_perm:[1,0,3,2] row_mask:0xf bank_mask:0xf
    v_add_f32_dpp v44, v44, v44 quad_perm:[2,3,0,1] row_mask:0xf bank_mask:0xf
    v_add_f32_dpp v45, v45, v45 quad_perm:[2,3,0,1] row_mask:0xf bank_mask:0xf
    v_add_f32_dpp v46, v46, v46 quad_perm:[2,3,0,1] row_mask:0xf bank_mask:0xf
    v_add_f32_dpp v44, v44, v44 row_half_mirror row_mask:0xf bank_mask:0xf
    v_add_f32_dpp v45, v45, v45 row_half_mirror row_mask:0xf bank_mask:0xf
    v_add_f32_dpp v46, v46, v46 row_half_mirror row_mask:0xf bank_mask:0xf
    v_mul_f32 v44, 0x3b000000, v44
    v_mul_f32 v45, 0x3b000000, v45
    v_fma_f32 v45, -v44, v44, v45
    v_max_f32 v45, 0, v45
    v_add_f32 v45, 0x3727c5ac, v45
    v_rsq_f32 v45, v45
    v_fma_f32 v46, -v44, v252, v46
    v_mul_f32 v46, v46, v45
    v_ashrrev_i32 v58, 31, v46
    v_or_b32 v58, 0x80000000, v58
    v_xor_b32 v58, v58, v46
    v_and_or_b32 v58, v58, s66, v8
    s_nop 1
    v_mov_b32_dpp v60, v58 row_ror:8 row_mask:0xf bank_mask:0xf
    v_mov_b32_dpp v61, v59 row_ror:8 row_mask:0xf bank_mask:0xf
    v_max_u32 v59, v59, v61
    v_med3_u32 v59, v58, v60, v59
    v_max_u32 v58, v58, v60
    v_mov_b32 v60, v58
    v_mov_b32 v61, v59
    s_nop 1
    v_permlane16_swap_b32 v58, v60
    v_permlane16_swap_b32 v59, v61
    s_nop 0
    v_max_u32 v59, v59, v61
    v_med3_u32 v59, v58, v60, v59
    v_max_u32 v58, v58, v60
    v_mov_b32 v60, v58
    v_mov_b32 v61, v59
    s_nop 1
    v_permlane32_swap_b32 v58, v60
    v_permlane32_swap_b32 v59, v61
    s_nop 0
    v_max_u32 v59, v59, v61
    v_med3_u32 v59, v58, v60, v59
    v_max_u32 v58, v58, v60
    ds_write_b64 v11, v[58:59]
    s_waitcnt lgkmcnt(0)
    s_barrier
    s_cmp_eq_u32 s52, 0
    s_cbranch_scc1 K_W0
    s_cmp_eq_u32 s54, 0
    s_cbranch_scc1 K_STG_DONE
    s_cmp_eq_u32 s59, 0
    s_cbranch_scc1 K_STG_DONE
    s_mov_b32 s63, s53
    v_lshrrev_b32 v8, 1, v1
    v_and_b32 v10, 1, v1
    v_lshlrev_b32 v10, 4, v10
    s_lshl_b32 s61, s60, 5
    s_cmp_eq_u32 s59, 1
    s_cbranch_scc0 K_FFN_D
    s_mov_b32 s44, s18
    s_mov_b32 s45, s19
    s_mov_b32 s46, 0x158000
    s_mov_b32 s47, 0x20000
    s_mov_b32 s48, s20
    s_mov_b32 s49, s21
    s_mov_b32 s50, 0x158000
    s_mov_b32 s51, 0x20000
    v_mul_u32_u24 v8, 2752, v8
    v_add_u32 v8, v8, v10
    s_mul_i32 s62, s63, 352256
    s_add_u32 s61, s61, s62
    s_lshl_b32 s62, s63, 12
    s_add_u32 s63, s62, 0
    s_mov_b32 m0, s63
    s_add_u32 s63, s62, 16512
    buffer_load_dwordx4 v8, s[44:47], s61 offen lds
    s_mov_b32 m0, s63
    s_nop 0
    buffer_load_dwordx4 v8, s[48:51], s61 offen lds
    s_add_u32 s61, s61, 88064
    s_add_u32 s63, s62, 1024
    s_mov_b32 m0, s63
    s_add_u32 s63, s62, 17536
    buffer_load_dwordx4 v8, s[44:47], s61 offen lds
    s_mov_b32 m0, s63
    s_nop 0
    buffer_load_dwordx4 v8, s[48:51], s61 offen lds
    s_add_u32 s61, s61, 88064
    s_add_u32 s63, s62, 2048
    s_mov_b32 m0, s63
    s_add_u32 s63, s62, 18560
    buffer_load_dwordx4 v8, s[44:47], s61 offen lds
    s_mov_b32 m0, s63
    s_nop 0
    buffer_load_dwordx4 v8, s[48:51], s61 offen lds
    s_add_u32 s61, s61, 88064
    s_add_u32 s63, s62, 3072
    s_mov_b32 m0, s63
    s_add_u32 s63, s62, 19584
    buffer_load_dwordx4 v8, s[44:47], s61 offen lds
    s_mov_b32 m0, s63
    s_nop 0
    buffer_load_dwordx4 v8, s[48:51], s61 offen lds
    s_add_u32 s61, s61, 88064
    s_branch K_STG_DONE
K_FFN_D:
    s_mov_b32 s44, s22
    s_mov_b32 s45, s23
    s_mov_b32 s46, 0x158000
    s_mov_b32 s47, 0x20000
    v_lshl_add_u32 v8, v8, 10, v10
    s_lshl_b32 s62, s63, 15
    s_add_u32 s61, s61, s62
    s_lshl_b32 s62, s63, 10
    s_add_u32 s62, s62, 0
K_FFN_DL:
    s_mov_b32 m0, s62
    s_add_u32 s62, s62, 4096
    buffer_load_dwordx4 v8, s[44:47], s61 offen lds
    s_add_u32 s61, s61, 0x20000
    s_cmp_lt_u32 s62, 44032
    s_cbranch_scc1 K_FFN_DL
K_STG_DONE:
    v_sub_f32 v72, v64, v44
    v_fmac_f32 v64, v72, v45
    v_sub_f32 v73, v65, v44
    v_fmac_f32 v65, v73, v45
    v_sub_f32 v74, v66, v44
    v_fmac_f32 v66, v74, v45
    v_sub_f32 v75, v67, v44
    v_fmac_f32 v67, v75, v45
    v_sub_f32 v76, v68, v44
    v_fmac_f32 v68, v76, v45
    v_sub_f32 v77, v69, v44
    v_fmac_f32 v69, v77, v45
    v_sub_f32 v78, v70, v44
    v_fmac_f32 v70, v78, v45
    v_sub_f32 v79, v71, v44
    v_fmac_f32 v71, v79, v45
    v_cvt_pk_bf16_f32 v36, v64, v65
    v_cvt_pk_bf16_f32 v37, v66, v67
    v_cvt_pk_bf16_f32 v38, v68, v69
    v_cvt_pk_bf16_f32 v39, v70, v71
    s_waitcnt vmcnt(0)
    s_branch K_L2WAIT
K_W0:
    v_and_b32 v10, 7, v1
    v_lshlrev_b32 v10, 3, v10
    v_add_u32 v10, 155648, v10
    ds_read_b64 v[58:59], v10
    v_lshlrev_b32 v10, 6, v2
    s_mov_b32 s61, 0x860000
    s_lshl_b32 s63, s15, 6
    s_add_u32 s63, s63, s61
    s_and_b32 s68, s15, 7
    s_cmp_eq_u32 s68, s14
    s_cbranch_scc0 K_NOPUB2
    s_waitcnt lgkmcnt(0)
    s_nop 1
    v_mov_b32_dpp v60, v58 quad_perm:[1,0,3,2] row_mask:0xf bank_mask:0xf
    v_mov_b32_dpp v61, v59 quad_perm:[1,0,3,2] row_mask:0xf bank_mask:0xf
    v_max_u32 v59, v59, v61
    v_med3_u32 v59, v58, v60, v59
    v_max_u32 v58, v58, v60
    s_nop 1
    v_mov_b32_dpp v60, v58 quad_perm:[2,3,0,1] row_mask:0xf bank_mask:0xf
    v_mov_b32_dpp v61, v59 quad_perm:[2,3,0,1] row_mask:0xf bank_mask:0xf
    v_max_u32 v59, v59, v61
    v_med3_u32 v59, v58, v60, v59
    v_max_u32 v58, v58, v60
    s_nop 1
    v_mov_b32_dpp v60, v58 row_half_mirror row_mask:0xf bank_mask:0xf
    v_mov_b32_dpp v61, v59 row_half_mirror row_mask:0xf bank_mask:0xf
    v_max_u32 v59, v59, v61
    v_med3_u32 v59, v58, v60, v59
    v_max_u32 v58, v58, v60
    v_mov_b32 v104, v58
    v_mov_b32 v105, v59
    v_mov_b32 v106, v12
    v_mov_b32 v107, v13
    s_mov_b64 exec, 1
    buffer_store_dwordx4 v[104:107], v10, s[40:43], s63 offen sc1
    s_mov_b64 exec, -1
K_NOPUB2:
    v_sub_f32 v72, v64, v44
    v_fmac_f32 v64, v72, v45
    v_sub_f32 v73, v65, v44
    v_fmac_f32 v65, v73, v45
    v_sub_f32 v74, v66, v44
    v_fmac_f32 v66, v74, v45
    v_sub_f32 v75, v67, v44
    v_fmac_f32 v67, v75, v45
    v_sub_f32 v76, v68, v44
    v_fmac_f32 v68, v76, v45
    v_sub_f32 v77, v69, v44
    v_fmac_f32 v69, v77, v45
    v_sub_f32 v78, v70, v44
    v_fmac_f32 v70, v78, v45
    v_sub_f32 v79, v71, v44
    v_fmac_f32 v71, v79, v45
    v_cvt_pk_bf16_f32 v36, v64, v65
    v_cvt_pk_bf16_f32 v37, v66, v67
    v_cvt_pk_bf16_f32 v38, v68, v69
    v_cvt_pk_bf16_f32 v39, v70, v71
    s_mov_b32 s6, 0
    s_mov_b32 exec_hi, 0
K_POLL2:
    buffer_load_dwordx4 v[108:111], v10, s[40:43], s61 offen sc1
    s_waitcnt vmcnt(0)
    v_cmp_eq_u64 vcc, v[110:111], v[12:13]
    s_cmp_eq_u64 vcc, exec
    s_cbranch_scc1 K_POLL2_OK
    s_add_u32 s6, s6, 1
    s_cmp_lt_u32 s6, 100000
    s_cbranch_scc1 K_POLL2
K_POLL2_OK:
    s_mov_b64 exec, -1
    s_waitcnt lgkmcnt(0)
    v_mov_b32 v58, v108
    v_mov_b32 v59, v109
    s_nop 1
    v_mov_b32_dpp v60, v58 quad_perm:[1,0,3,2] row_mask:0xf bank_mask:0xf
    v_mov_b32_dpp v61, v59 quad_perm:[1,0,3,2] row_mask:0xf bank_mask:0xf
    v_max_u32 v59, v59, v61
    v_med3_u32 v59, v58, v60, v59
    v_max_u32 v58, v58, v60
    s_nop 1
    v_mov_b32_dpp v60, v58 quad_perm:[2,3,0,1] row_mask:0xf bank_mask:0xf
    v_mov_b32_dpp v61, v59 quad_perm:[2,3,0,1] row_mask:0xf bank_mask:0xf
    v_max_u32 v59, v59, v61
    v_med3_u32 v59, v58, v60, v59
    v_max_u32 v58, v58, v60
    s_nop 1
    v_mov_b32_dpp v60, v58 row_half_mirror row_mask:0xf bank_mask:0xf
    v_mov_b32_dpp v61, v59 row_half_mirror row_mask:0xf bank_mask:0xf
    v_max_u32 v59, v59, v61
    v_med3_u32 v59, v58, v60, v59
    v_max_u32 v58, v58, v60
    s_nop 1
    v_mov_b32_dpp v60, v58 row_mirror row_mask:0xf bank_mask:0xf
    v_mov_b32_dpp v61, v59 row_mirror row_mask:0xf bank_mask:0xf
    v_max_u32 v59, v59, v61
    v_med3_u32 v59, v58, v60, v59
    v_max_u32 v58, v58, v60
    v_mov_b32 v60, v58
    v_mov_b32 v61, v59
    s_nop 1
    v_permlane16_swap_b32 v58, v60
    v_permlane16_swap_b32 v59, v61
    s_nop 0
    v_max_u32 v59, v59, v61
    v_med3_u32 v59, v58, v60, v59
    v_max_u32 v58, v58, v60
    s_mov_b64 exec, 1
    ds_write_b64 v11, v[58:59] offset:64
    s_mov_b64 exec, -1
    s_waitcnt lgkmcnt(0)
K_L2WAIT:
    v_mov_b32 v11, 155712
    v_mov_b32 v125, 0
    s_barrier
    ds_read_b64 v[58:59], v11
    s_waitcnt lgkmcnt(0)
    v_readfirstlane_b32 s65, v58
    v_readfirstlane_b32 s66, v59
    s_and_b32 s65, s65, 0x7ff
    s_sub_u32 s65, 2047, s65
    s_and_b32 s66, s66, 0x7ff
    s_sub_u32 s66, 2047, s66
    s_cmp_eq_u32 s59, 0
    s_cbranch_scc1 K_OWN
    s_lshr_b32 s4, s60, 2
    s_and_b32 s3, s60, 3
    s_cmp_eq_u32 s59, 1
    s_cselect_b32 s4, s52, s4
    s_cselect_b32 s3, 0, s3
    s_cbranch_scc1 K_SEL
    s_cmp_eq_u32 s52, 0
    s_cbranch_scc0 K_OWN
K_SEL:
    v_mov_b32 v8, s65
    v_mov_b32 v10, s66
    s_mov_b32 vcc_lo, 0xaaaaaaaa
    s_mov_b32 vcc_hi, 0xaaaaaaaa
    v_cndmask_b32 v41, v8, v10, vcc
    v_lshlrev_b32 v41, 10, v41
    v_lshl_add_u32 v41, v3, 4, v41
    s_lshl_b32 s63, s4, 7
    s_add_u32 s63, s63, 0x600000
    s_mov_b32 exec_lo, 3
    s_mov_b32 exec_hi, 3
    s_add_u32 s68, s3, 0
    s_and_b32 s68, s68, 3
    s_lshl_b32 s68, s68, 5
    s_add_u32 s68, s68, s63
    buffer_load_dwordx4 v[80:83], v41, s[40:43], s68 offen sc1
    s_add_u32 s68, s3, 1
    s_and_b32 s68, s68, 3
    s_lshl_b32 s68, s68, 5
    s_add_u32 s68, s68, s63
    buffer_load_dwordx4 v[84:87], v41, s[40:43], s68 offen sc1
    s_add_u32 s68, s3, 2
    s_and_b32 s68, s68, 3
    s_lshl_b32 s68, s68, 5
    s_add_u32 s68, s68, s63
    buffer_load_dwordx4 v[88:91], v41, s[40:43], s68 offen sc1
    s_add_u32 s68, s3, 3
    s_and_b32 s68, s68, 3
    s_lshl_b32 s68, s68, 5
    s_add_u32 s68, s68, s63
    buffer_load_dwordx4 v[92:95], v41, s[40:43], s68 offen sc1
    s_mov_b64 exec, -1
    s_mov_b32 vcc_lo, 0xffff0000
    s_mov_b32 vcc_hi, 0xffff0000
    v_cndmask_b32 v8, v8, v10, vcc
    v_lshrrev_b32 v10, 6, v8
    v_lshlrev_b32 v10, 13, v10
    v_bfe_u32 v11, v8, 4, 2
    v_lshl_add_u32 v10, v11, 8, v10
    v_bfe_u32 v11, v8, 2, 1
    v_lshl_add_u32 v10, v11, 7, v10
    v_bfe_u32 v11, v8, 3, 1
    v_lshl_add_u32 v10, v11, 6, v10
    v_and_b32 v11, 3, v8
    v_lshl_add_u32 v10, v11, 4, v10
    v_and_b32 v11, 7, v1
    v_lshl_add_u32 v42, v11, 10, v10
    s_mov_b32 s68, 0x800000
    buffer_load_dwordx4 v[120:123], v42, s[40:43], s68 offen sc1
    v_and_b32 v10, 14, v1
    v_lshlrev_b32 v10, 1, v10
    v_lshl_add_u32 v125, v8, 10, v10
K_OWN:
    v_cmp_ne_u32 vcc, s65, v7
    v_cmp_ne_u32 s[68:69], s66, v7
    s_and_b64 exec, vcc, s[68:69]
    buffer_store_dwordx4 v[36:39], v9, s[36:39], s64 offen
    s_mov_b64 exec, -1
    s_cmp_eq_u32 s59, 0
    s_cbranch_scc1 K_FIN
    v_bfe_u32 v8, v1, 2, 2
    v_and_b32 v10, 3, v1
    s_cmp_eq_u32 s59, 1
    s_cbranch_scc0 K_FA_D
    v_lshl_add_u32 v8, v3, 3, v8
    s_lshl_b32 s68, s52, 11
    s_add_u32 s68, s68, 0
    v_lshl_add_u32 v8, v8, 5, s68
    v_lshl_add_u32 v8, v10, 3, v8
    v_bfe_u32 v10, v1, 4, 1
    v_mul_u32_u24 v10, 16512, v10
    v_add_u32 v8, v8, v10
    ds_read_b64_tr_b16 v[200:201], v8 offset:0
    ds_read_b64_tr_b16 v[202:203], v8 offset:128
    ds_read_b64_tr_b16 v[204:205], v8 offset:512
    ds_read_b64_tr_b16 v[206:207], v8 offset:640
    ds_read_b64_tr_b16 v[208:209], v8 offset:1024
    ds_read_b64_tr_b16 v[210:211], v8 offset:1152
    ds_read_b64_tr_b16 v[212:213], v8 offset:1536
    ds_read_b64_tr_b16 v[214:215], v8 offset:1664
    s_branch K_FA_DONE
K_FA_D:
    v_lshrrev_b32 v11, 4, v1
    v_lshl_add_u32 v8, v11, 3, v8
    s_lshl_b32 s68, s52, 10
    s_add_u32 s68, s68, 0
    v_lshl_add_u32 v8, v8, 5, s68
    v_lshl_add_u32 v8, v10, 3, v8
    ds_read_b64_tr_b16 v[200:201], v8 offset:0
    ds_read_b64_tr_b16 v[202:203], v8 offset:128
    ds_read_b64_tr_b16 v[204:205], v8 offset:8192
    ds_read_b64_tr_b16 v[206:207], v8 offset:8320
    ds_read_b64_tr_b16 v[208:209], v8 offset:16384
    ds_read_b64_tr_b16 v[210:211], v8 offset:16512
    ds_read_b64_tr_b16 v[212:213], v8 offset:24576
    ds_read_b64_tr_b16 v[214:215], v8 offset:24704
    ds_read_b64_tr_b16 v[216:217], v8 offset:32768
    ds_read_b64_tr_b16 v[218:219], v8 offset:32896
    s_cmp_lt_u32 s52, 3
    s_cbranch_scc0 K_FA_DONE
    ds_read_b64_tr_b16 v[220:221], v8 offset:40960
    ds_read_b64_tr_b16 v[222:223], v8 offset:41088
K_FA_DONE:
    s_cmp_eq_u32 s59, 1
    s_cbranch_scc0 K_DOWN
    v_lshlrev_b32 v8, 7, v2
    v_lshl_add_u32 v8, v3, 4, v8
    s_mul_i32 s61, s52, 384
    s_add_u32 s61, s61, 155904
    v_add_u32 v8, s61, v8
    s_mov_b32 s6, 0
    s_waitcnt vmcnt(1) lgkmcnt(0)
K_HCHK:
    v_mfma_f32_32x32x16_bf16 v[104:119], v[200:203], v[80:83], 0
    v_mfma_f32_32x32x16_bf16 v[104:119], v[204:207], v[84:87], v[104:119]
    v_mfma_f32_32x32x16_bf16 v[104:119], v[208:211], v[88:91], v[104:119]
    v_mfma_f32_32x32x16_bf16 v[104:119], v[212:215], v[92:95], v[104:119]
    v_add_u32 v10, v80, v81
    v_add3_u32 v10, v82, v83, v10
    v_add3_u32 v10, v84, v85, v10
    v_add3_u32 v10, v86, v87, v10
    v_add3_u32 v10, v88, v89, v10
    v_add3_u32 v10, v90, v91, v10
    v_add3_u32 v10, v92, v93, v10
    v_add3_u32 v10, v94, v95, v10
    v_max_u32 v11, v120, v121
    v_max3_u32 v11, v122, v123, v11
    s_add_u32 s62, s4, 16
    v_cmp_eq_u32 vcc, -1, v11
    v_readlane_b32 s68, v123, s4
    v_readlane_b32 s69, v123, s62
    v_readlane_b32 s61, v10, 0
    v_readlane_b32 s62, v10, 32
    s_add_u32 s61, s61, s62
    s_min_u32 s61, s61, -2
    s_xor_b32 s68, s68, s61
    v_readlane_b32 s61, v10, 1
    v_readlane_b32 s62, v10, 33
    s_add_u32 s61, s61, s62
    s_min_u32 s61, s61, -2
    s_xor_b32 s69, s69, s61
    s_or_b32 s68, s68, s69
    s_or_b32 s68, s68, vcc_lo
    s_or_b32 s68, s68, vcc_hi
    s_cbranch_scc0 K_HOK
    s_mov_b32 exec_lo, 3
    s_mov_b32 exec_hi, 3
    s_add_u32 s68, s3, 0
    s_and_b32 s68, s68, 3
    s_lshl_b32 s68, s68, 5
    s_add_u32 s68, s68, s63
    buffer_load_dwordx4 v[80:83], v41, s[40:43], s68 offen sc1
    s_add_u32 s68, s3, 1
    s_and_b32 s68, s68, 3
    s_lshl_b32 s68, s68, 5
    s_add_u32 s68, s68, s63
    buffer_load_dwordx4 v[84:87], v41, s[40:43], s68 offen sc1
    s_add_u32 s68, s3, 2
    s_and_b32 s68, s68, 3
    s_lshl_b32 s68, s68, 5
    s_add_u32 s68, s68, s63
    buffer_load_dwordx4 v[88:91], v41, s[40:43], s68 offen sc1
    s_add_u32 s68, s3, 3
    s_and_b32 s68, s68, 3
    s_lshl_b32 s68, s68, 5
    s_add_u32 s68, s68, s63
    buffer_load_dwordx4 v[92:95], v41, s[40:43], s68 offen sc1
    s_mov_b64 exec, -1
    s_mov_b32 s68, 0x800000
    buffer_load_dwordx4 v[120:123], v42, s[40:43], s68 offen sc1
    s_waitcnt vmcnt(0)
    s_add_u32 s6, s6, 1
    s_cmp_lt_u32 s6, 100000
    s_cbranch_scc1 K_HCHK
K_HOK:
    s_mov_b32 exec_lo, 7
    s_mov_b32 exec_hi, 7
    ds_write_b128 v8, v[104:107] offset:0
    ds_write_b128 v8, v[108:111] offset:32
    ds_write_b128 v8, v[112:115] offset:64
    ds_write_b128 v8, v[116:119] offset:96
    s_mov_b64 exec, -1
    s_cmp_eq_u32 s52, 0
    s_cbranch_scc1 K_GU_W0
    s_waitcnt lgkmcnt(0)
    s_barrier
    s_branch K_FIN
K_GU_W0:
    v_add_f32_dpp v120, v120, v120 quad_perm:[1,0,3,2] row_mask:0xf bank_mask:0xf
    v_add_f32_dpp v121, v121, v121 quad_perm:[1,0,3,2] row_mask:0xf bank_mask:0xf
    v_add_f32_dpp v122, v122, v122 quad_perm:[1,0,3,2] row_mask:0xf bank_mask:0xf
    v_add_f32_dpp v120, v120, v120 quad_perm:[2,3,0,1] row_mask:0xf bank_mask:0xf
    v_add_f32_dpp v121, v121, v121 quad_perm:[2,3,0,1] row_mask:0xf bank_mask:0xf
    v_add_f32_dpp v122, v122, v122 quad_perm:[2,3,0,1] row_mask:0xf bank_mask:0xf
    v_add_f32_dpp v120, v120, v120 row_half_mirror row_mask:0xf bank_mask:0xf
    v_add_f32_dpp v121, v121, v121 row_half_mirror row_mask:0xf bank_mask:0xf
    v_add_f32_dpp v122, v122, v122 row_half_mirror row_mask:0xf bank_mask:0xf
    v_mul_f32 v120, 0x3b000000, v120
    v_mul_f32 v121, 0x3b000000, v121
    v_fma_f32 v121, -v120, v120, v121
    v_max_f32 v121, 0, v121
    v_add_f32 v121, 0x3727c5ac, v121
    v_rsq_f32 v121, v121
    v_bfe_u32 v8, v1, 4, 1
    v_and_b32 v10, 15, v1
    v_lshlrev_b32 v11, 2, v10
    v_mul_u32_u24 v10, 1536, v3
    v_add_u32 v11, v11, v10
    v_add_u32 v11, 155904, v11
    v_lshl_add_u32 v10, v8, 7, v11
    v_add_u32 v60, 768, v10
    v_add_u32 v61, 768, v11
    v_lshlrev_b32 v8, 1, v1
    s_lshl_b32 s61, s60, 6
    s_add_u32 s61, s61, 0x840000
    s_waitcnt lgkmcnt(0)
    s_barrier
    ds_read2_b32 v[64:65], v10 offset0:0 offset1:16
    ds_read2_b32 v[66:67], v11 offset0:64 offset1:80
    ds_read2_b32 v[68:69], v10 offset0:96 offset1:112
    ds_read2_b32 v[70:71], v11 offset0:160 offset1:176
    ds_read2_b32 v[72:73], v60 offset0:0 offset1:16
    ds_read2_b32 v[74:75], v61 offset0:64 offset1:80
    ds_read2_b32 v[76:77], v60 offset0:96 offset1:112
    ds_read2_b32 v[78:79], v61 offset0:160 offset1:176
    s_waitcnt lgkmcnt(0)
    v_add_f32 v64, v64, v68
    v_add_f32 v72, v72, v76
    v_add_f32 v65, v65, v69
    v_add_f32 v73, v73, v77
    v_add_f32 v66, v66, v70
    v_add_f32 v74, v74, v78
    v_add_f32 v67, v67, v71
    v_add_f32 v75, v75, v79
    v_add_f32 v64, v64, v72
    v_add_f32 v65, v65, v73
    v_add_f32 v66, v66, v74
    v_add_f32 v67, v67, v75
    v_mov_b32 v68, v64
    v_mov_b32 v69, v65
    v_mov_b32 v70, v66
    v_mov_b32 v71, v67
    s_nop 0
    v_permlane32_swap_b32 v64, v68
    v_permlane32_swap_b32 v65, v69
    v_permlane32_swap_b32 v66, v70
    v_permlane32_swap_b32 v67, v71
    v_add_f32 v64, v64, v68
    v_add_f32 v65, v65, v69
    v_add_f32 v66, v66, v70
    v_add_f32 v67, v67, v71
    v_fma_f32 v64, -v120, v66, v64
    v_fma_f32 v65, -v120, v67, v65
    v_mul_f32 v64, v64, v121
    v_mul_f32 v65, v65, v121
    v_mul_f32 v66, 0xbfb8aa3b, v64
    v_exp_f32 v66, v66
    v_mul_f32 v64, v64, v65
    v_add_f32 v66, 1.0, v66
    v_rcp_f32 v66, v66
    s_nop 0
    v_mul_f32 v64, v64, v66
    s_nop 1
    v_mov_b32_dpp v65, v64 quad_perm:[1,0,3,2] row_mask:0xf bank_mask:0xf
    v_cvt_pk_bf16_f32 v66, v64, v65
    v_min_u32 v66, -2, v66
    s_mov_b32 exec_lo, 0x55555555
    s_mov_b32 exec_hi, 0
    buffer_store_dword v66, v8, s[40:43], s61 offen sc1
    s_mov_b64 exec, -1
    s_branch K_FIN
K_DOWN:
    s_cmp_eq_u32 s52, 0
    s_cbranch_scc0 K_D_POLL
    s_mov_b32 s6, 0
    s_waitcnt vmcnt(0)
K_DH:
    v_add_u32 v10, v80, v81
    v_add3_u32 v10, v82, v83, v10
    v_add3_u32 v10, v84, v85, v10
    v_add3_u32 v10, v86, v87, v10
    v_add3_u32 v10, v88, v89, v10
    v_add3_u32 v10, v90, v91, v10
    v_add3_u32 v10, v92, v93, v10
    v_add3_u32 v10, v94, v95, v10
    v_max_u32 v11, v120, v121
    v_max3_u32 v11, v122, v123, v11
    s_add_u32 s62, s4, 16
    v_cmp_eq_u32 vcc, -1, v11
    v_readlane_b32 s68, v123, s4
    v_readlane_b32 s69, v123, s62
    v_readlane_b32 s61, v10, 0
    v_readlane_b32 s62, v10, 32
    s_add_u32 s61, s61, s62
    s_min_u32 s61, s61, -2
    s_xor_b32 s68, s68, s61
    v_readlane_b32 s61, v10, 1
    v_readlane_b32 s62, v10, 33
    s_add_u32 s61, s61, s62
    s_min_u32 s61, s61, -2
    s_xor_b32 s69, s69, s61
    s_or_b32 s68, s68, s69
    s_or_b32 s68, s68, vcc_lo
    s_or_b32 s68, s68, vcc_hi
    s_cbranch_scc0 K_DH_OK
    s_mov_b32 exec_lo, 3
    s_mov_b32 exec_hi, 3
    s_add_u32 s68, s3, 0
    s_and_b32 s68, s68, 3
    s_lshl_b32 s68, s68, 5
    s_add_u32 s68, s68, s63
    buffer_load_dwordx4 v[80:83], v41, s[40:43], s68 offen sc1
    s_add_u32 s68, s3, 1
    s_and_b32 s68, s68, 3
    s_lshl_b32 s68, s68, 5
    s_add_u32 s68, s68, s63
    buffer_load_dwordx4 v[84:87], v41, s[40:43], s68 offen sc1
    s_add_u32 s68, s3, 2
    s_and_b32 s68, s68, 3
    s_lshl_b32 s68, s68, 5
    s_add_u32 s68, s68, s63
    buffer_load_dwordx4 v[88:91], v41, s[40:43], s68 offen sc1
    s_add_u32 s68, s3, 3
    s_and_b32 s68, s68, 3
    s_lshl_b32 s68, s68, 5
    s_add_u32 s68, s68, s63
    buffer_load_dwordx4 v[92:95], v41, s[40:43], s68 offen sc1
    s_mov_b64 exec, -1
    s_mov_b32 s68, 0x800000
    buffer_load_dwordx4 v[120:123], v42, s[40:43], s68 offen sc1
    s_waitcnt vmcnt(0)
    s_add_u32 s6, s6, 1
    s_cmp_lt_u32 s6, 100000
    s_cbranch_scc1 K_DH
K_DH_OK:
    v_lshlrev_b32 v8, 5, v2
    v_lshl_add_u32 v8, v3, 4, v8
    v_add_u32 v8, 155776, v8
    s_mov_b32 exec_lo, 3
    s_mov_b32 exec_hi, 3
    ds_write_b128 v8, v[80:83]
    s_mov_b64 exec, -1
    v_and_b32 v8, 30, v1
    v_lshlrev_b32 v8, 1, v8
    v_add_u32 v8, 155776, v8
    s_waitcnt lgkmcnt(0)
    ds_read_b32 v124, v8
    s_waitcnt lgkmcnt(0)
    v_add_f32_dpp v120, v120, v120 quad_perm:[1,0,3,2] row_mask:0xf bank_mask:0xf
    v_add_f32_dpp v121, v121, v121 quad_perm:[1,0,3,2] row_mask:0xf bank_mask:0xf
    v_add_f32_dpp v122, v122, v122 quad_perm:[1,0,3,2] row_mask:0xf bank_mask:0xf
    v_add_f32_dpp v120, v120, v120 quad_perm:[2,3,0,1] row_mask:0xf bank_mask:0xf
    v_add_f32_dpp v121, v121, v121 quad_perm:[2,3,0,1] row_mask:0xf bank_mask:0xf
    v_add_f32_dpp v122, v122, v122 quad_perm:[2,3,0,1] row_mask:0xf bank_mask:0xf
    v_add_f32_dpp v120, v120, v120 row_half_mirror row_mask:0xf bank_mask:0xf
    v_add_f32_dpp v121, v121, v121 row_half_mirror row_mask:0xf bank_mask:0xf
    v_add_f32_dpp v122, v122, v122 row_half_mirror row_mask:0xf bank_mask:0xf
    v_mul_f32 v120, 0x3b000000, v120
    v_mul_f32 v121, 0x3b000000, v121
    v_fma_f32 v121, -v120, v120, v121
    v_max_f32 v121, 0, v121
    v_add_f32 v121, 0x3727c5ac, v121
    v_rsq_f32 v121, v121
    v_lshlrev_b32 v64, 16, v124
    v_and_b32 v124, 0xffff0000, v124
    v_fma_f32 v122, -v120, v252, v122
    v_mul_f32 v122, v122, v121
    v_mul_f32 v122, 0xbfb8aa3b, v122
    v_exp_f32 v122, v122
    s_mov_b32 vcc_lo, 0x55555555
    s_mov_b32 vcc_hi, 0x55555555
    v_cndmask_b32 v124, v124, v64, vcc
    v_add_f32 v122, 1.0, v122
    v_rcp_f32 v122, v122
    v_sub_f32 v65, v124, v120
    v_fmac_f32 v124, v65, v121
K_D_POLL:
    v_and_b32 v8, 1, v1
    v_lshlrev_b32 v8, 5, v8
    v_lshl_add_u32 v8, v3, 6, v8
    v_bfe_u32 v10, v1, 4, 1
    v_lshl_add_u32 v8, v10, 4, v8
    v_lshrrev_b32 v10, 4, v1
    s_lshl_b32 s68, s52, 7
    s_add_u32 s61, s68, 0x840000
    s_add_u32 s63, s61, 4096
    v_and_b32 v11, 15, v1
    v_lshlrev_b32 v11, 6, v11
    v_lshl_add_u32 v11, v10, 4, v11
    s_add_u32 s68, s68, 155904
    v_add_u32 v11, s68, v11
    s_mov_b32 exec_lo, 0x00030003
    s_mov_b32 exec_hi, 0x00030003
    s_mov_b32 s6, 0
K_POLLA:
    buffer_load_dwordx4 v[80:83], v8, s[40:43], s61 offen offset:0 sc1
    buffer_load_dwordx4 v[84:87], v8, s[40:43], s61 offen offset:1024 sc1
    buffer_load_dwordx4 v[88:91], v8, s[40:43], s61 offen offset:2048 sc1
    buffer_load_dwordx4 v[92:95], v8, s[40:43], s61 offen offset:3072 sc1
    buffer_load_dwordx4 v[96:99], v8, s[40:43], s63 offen sc1
    s_cmp_lt_u32 s52, 3
    s_cbranch_scc0 K_POLLA5
    buffer_load_dwordx4 v[100:103], v8, s[40:43], s63 offen offset:1024 sc1
K_POLLA5:
    s_waitcnt vmcnt(0) lgkmcnt(0)
    v_max_u32 v10, v80, v81
    v_max3_u32 v10, v82, v83, v10
    v_max3_u32 v10, v84, v85, v10
    v_max3_u32 v10, v86, v87, v10
    v_max3_u32 v10, v88, v89, v10
    v_max3_u32 v10, v90, v91, v10
    v_max3_u32 v10, v92, v93, v10
    v_max3_u32 v10, v94, v95, v10
    v_max3_u32 v10, v96, v97, v10
    v_max3_u32 v10, v98, v99, v10
    v_max3_u32 v10, v100, v101, v10
    v_max3_u32 v10, v102, v103, v10
    v_cmp_eq_u32 vcc, -1, v10
    s_cmp_eq_u64 vcc, 0
    s_cbranch_scc1 K_POLLA_OK
    s_add_u32 s6, s6, 1
    s_cmp_lt_u32 s6, 100000
    s_cbranch_scc1 K_POLLA
K_POLLA_OK:
    s_mov_b64 exec, -1
    v_mfma_f32_16x16x32_bf16 v[104:107], v[200:203], v[80:83], 0
    v_mfma_f32_16x16x32_bf16 v[104:107], v[204:207], v[84:87], v[104:107]
    v_mfma_f32_16x16x32_bf16 v[104:107], v[208:211], v[88:91], v[104:107]
    v_mfma_f32_16x16x32_bf16 v[104:107], v[212:215], v[92:95], v[104:107]
    v_mfma_f32_16x16x32_bf16 v[104:107], v[216:219], v[96:99], v[104:107]
    s_cmp_lt_u32 s52, 3
    s_cbranch_scc0 K_D5
    v_mfma_f32_16x16x32_bf16 v[104:107], v[220:223], v[100:103], v[104:107]
K_D5:
    v_lshlrev_b32 v8, 2, v2
    v_lshl_add_u32 v8, v3, 9, v8
    v_add_u32 v8, 155904, v8
    s_mov_b32 exec_lo, 0x00030003
    s_mov_b32 exec_hi, 0x00030003
    s_nop 2
    ds_write_b128 v11, v[104:107]
    s_mov_b64 exec, -1
    s_waitcnt lgkmcnt(0)
    s_barrier
    s_cmp_eq_u32 s52, 0
    s_cbranch_scc0 K_FIN
    ds_read2_b32 v[66:67], v8 offset0:0 offset1:32
    ds_read2_b32 v[68:69], v8 offset0:64 offset1:96
    s_lshl_b32 s61, s60, 5
    s_waitcnt lgkmcnt(0)
    v_add_f32 v66, v66, v67
    v_add_f32 v68, v68, v69
    v_add_f32 v64, v66, v68
    v_mov_b32 v66, v64
    s_nop 1
    v_permlane32_swap_b32 v64, v66
    s_nop 0
    v_add_f32 v64, v64, v66
    v_fmac_f32 v124, v64, v122
    s_nop 1
    v_mov_b32_dpp v64, v124 quad_perm:[1,0,3,2] row_mask:0xf bank_mask:0xf
    v_cvt_pk_bf16_f32 v124, v124, v64
    s_mov_b32 exec_lo, 0x55555555
    s_mov_b32 exec_hi, 0
    buffer_store_dword v124, v125, s[36:39], s61 offen
    s_mov_b64 exec, -1
K_FIN:
K_END:
    s_endpgm
.section .rodata,"a"
.p2align 6
.amdhsa_kernel sequential_preLN__sliding_block__moe_arch_mod__prompt_kernel
  .amdhsa_next_free_vgpr 256
  .amdhsa_next_free_sgpr 102
  .amdhsa_accum_offset 256
  .amdhsa_group_segment_fixed_size 0
  .amdhsa_kernarg_size 88
  .amdhsa_user_sgpr_count 2
  .amdhsa_user_sgpr_kernarg_segment_ptr 1
  .amdhsa_system_sgpr_workgroup_id_x 1
.end_amdhsa_kernel
```
